```python
import torch

def _softmax(x, axis=-1):
    return torch.softmax(x, dim=axis)
def _gelu(x):
    return torch.nn.functional.gelu(x, approximate="tanh")
def _silu(x):
    return torch.nn.functional.silu(x)
def _sigmoid(x):
    return torch.sigmoid(x)
def _layernorm(x, axis=-1, eps=1e-5):
    m = x.mean(dim=axis, keepdim=True)
    v = x.var(dim=axis, keepdim=True, unbiased=False)
    return (x - m) / torch.sqrt(v + eps)
def _scatter_add(tgt, idx, src, axis=0):
    return tgt.clone().index_add_(axis, idx, src)
def _segment_sum(src, seg, n):
    out = torch.zeros((n,) + src.shape[1:], dtype=src.dtype)
    return out.index_add_(0, seg, src)
def _pad(x, pw):
    flat = tuple(v for pair in reversed(pw) for v in pair)
    return torch.nn.functional.pad(x, flat)

kernel_name = 'standalone__adm_resblock__diffusion'

def setup_inputs():

    _w = (lambda a: (lambda t: t.to(torch.bfloat16) if t.is_floating_point() else t)(torch.as_tensor(a)))
    B, C, HW, E = 2, 128, 128, 1152
    sc = (9.0 * C) ** -0.5
    return {
        "x": _w((lambda *s: torch.randn(*s, dtype=torch.bfloat16) * 0.05)(B, C, HW, HW)),
        "t_emb": _w((lambda *s: torch.randn(*s, dtype=torch.bfloat16) * 0.4)(B, E)),
        "g1": _w(1.0 + 0.1 * (lambda *s: torch.randn(*s, dtype=torch.bfloat16) * 0.4)(C)),
        "be1": _w(0.1 * (lambda *s: torch.randn(*s, dtype=torch.bfloat16) * 0.4)(C)),
        "w1": _w((lambda *s: torch.randn(*s, dtype=torch.bfloat16) * 0.4)(C, C, 3, 3) * sc),
        "w_emb": _w((lambda *s: torch.randn(*s, dtype=torch.bfloat16) * 0.4)(E, C) * (E ** -0.5)),
        "g2": _w(1.0 + 0.1 * (lambda *s: torch.randn(*s, dtype=torch.bfloat16) * 0.4)(C)),
        "be2": _w(0.1 * (lambda *s: torch.randn(*s, dtype=torch.bfloat16) * 0.4)(C)),
        "w2": _w((lambda *s: torch.randn(*s, dtype=torch.bfloat16) * 0.4)(C, C, 3, 3) * sc),
    }

def reference(x, t_emb, g1, be1, w1, w_emb, g2, be2, w2):
    B, C, H, W = x.shape
    G, eps = 4, 1e-5
    def gn(z, gamma, beta):
        zr = z.reshape(B, G, (C // G) * H * W)
        mu = zr.mean(-1).reshape(B, G, 1)
        var = ((zr - mu) ** 2).mean(-1).reshape(B, G, 1)
        zn = ((zr - mu) / torch.sqrt(var + eps)).reshape(B, C, H, W)
        return zn * gamma.reshape(1, C, 1, 1) + beta.reshape(1, C, 1, 1)
    def conv3(z, w):
        zp = _pad(z, ((0, 0), (0, 0), (1, 1), (1, 1)))
        taps = [torch.einsum("bchw,oc->bohw", zp[:, :, i:i+H, j:j+W], w[:, :, i, j]) for i in range(3) for j in range(3)]
        out = taps[0]
        for t in taps[1:]:
            out = out + t
        return out
    h = conv3(_silu(gn(x, g1, be1)), w1)
    emb = _silu(t_emb) @ w_emb
    h = h + emb.reshape(B, C, 1, 1)
    h = conv3(_silu(gn(h, g2, be2)), w2)
    return x + h
```

```asm
; @launch grid=(256,1,1) block=(256,1,1) lds=128640
.amdgcn_target "amdgcn-amd-amdhsa--gfx950"
.text
.globl standalone__adm_resblock__diffusion_kernel
.p2align 8
.type standalone__adm_resblock__diffusion_kernel,@function
standalone__adm_resblock__diffusion_kernel:
    s_cmp_ge_u32 s2, 256
    s_cbranch_scc1 L_end
    s_load_dwordx16 s[4:19], s[0:1], 0
    s_load_dwordx8 s[20:27], s[0:1], 64
    s_getpc_b64 s[98:99]
L_pc:
    s_lshr_b32 s3, s2, 3
    s_and_b32 s3, s3, 31
    s_lshl_b32 s3, s3, 10
    v_and_b32 v2, 7, v0
    v_lshl_add_u32 v2, v2, 7, s3
    v_min_u32 v2, L_codeend-L_pc-4, v2
    global_load_dword v127, v2, s[98:99]
    v_lshrrev_b32 v2, 6, v0
    v_and_b32 v1, 63, v0
    v_readfirstlane_b32 s70, v2
    s_and_b32 s3, s2, 7
    s_lshr_b32 s56, s2, 3
    s_lshr_b32 s71, s3, 2
    s_and_b32 s3, s3, 3
    s_lshl_b32 s72, s3, 5
    s_and_b32 s57, s56, 0x1c
    s_add_u32 s72, s72, s57
    s_and_b32 s57, s56, 3
    s_add_u32 s74, s72, s57
    s_lshl_b32 s73, s57, 5
    v_min_u32 v60, 35, v1
    v_mul_u32_u24 v61, 57, v60
    v_lshrrev_b32 v61, 9, v61
    v_mul_u32_u24 v62, 9, v61
    v_sub_u32 v62, v60, v62
    s_lshr_b32 s56, s74, 4
    s_and_b32 s57, s74, 15
    s_lshl_b32 s58, s70, 5
    s_lshl_b32 s59, s56, 2
    s_add_u32 s58, s58, s59
    s_mul_i32 s58, s58, 2304
    s_mul_i32 s59, s57, 144
    s_add_u32 s58, s58, s59
    v_mul_u32_u24 v63, 2304, v61
    v_lshl_add_u32 v63, v62, 4, v63
    v_add_u32 v63, s58, v63
    v_and_b32 v50, 3, v1
    v_bfe_u32 v52, v1, 2, 2
    v_lshrrev_b32 v53, 4, v1
    s_lshl_b32 s56, s71, 22
    s_lshl_b32 s57, s70, 20
    s_add_u32 s56, s56, s57
    s_lshl_b32 s57, s73, 1
    s_add_u32 s56, s56, s57
    s_lshl_b32 s57, s72, 8
    s_add_u32 s57, s57, s56
    v_lshl_add_u32 v55, v50, 4, s57
    v_lshl_add_u32 v55, v52, 8, v55
    v_lshl_add_u32 v55, v53, 17, v55
    v_add_u32 v56, 524288, v55
    s_mov_b32 s30, 8388608
    s_mov_b32 s31, 0x20000
    s_mov_b32 s34, 131072
    s_mov_b32 s35, 0x20000
    s_mov_b32 s65, 32768
    s_mov_b32 s66, 65536
    s_mov_b32 s67, 98304
    s_waitcnt lgkmcnt(0)
    global_load_dwordx4 v[64:67], v63, s[12:13]
    global_load_dwordx4 v[68:71], v63, s[20:21]
    s_mov_b32 s28, s4
    s_mov_b32 s29, s5
    s_mov_b32 s32, s26
    s_mov_b32 s33, s27
    buffer_load_dword v8, off, s[32:35], 0 sc1
    buffer_load_dwordx4 v[132:135], v55, s[28:31], 0 offen
    s_mul_i32 s56, s71, 589824
    s_add_u32 s56, s56, 131072
    s_add_u32 s36, s26, s56
    s_addc_u32 s37, s27, 0
    s_mov_b32 s38, 589824
    s_mov_b32 s39, 0x20000
    s_mul_i32 s56, s70, 15744
    s_add_u32 s56, s56, 71680
    v_lshl_add_u32 v58, v60, 4, s56
    v_mul_u32_u24 v59, 144, v61
    v_lshl_add_u32 v59, v62, 1, v59
    v_add_u32 v59, s56, v59
    v_mul_u32_u24 v122, 86, v62
    v_lshrrev_b32 v122, 8, v122
    v_mul_u32_u24 v123, 3, v122
    v_sub_u32 v123, v62, v123
    v_mul_u32_u24 v123, 3, v123
    v_add_u32 v123, v123, v122
    v_lshlrev_b32 v123, 10, v123
    buffer_load_dwordx4 v[140:143], v55, s[28:31], s65 offen
    v_lshl_add_u32 v123, v61, 4, v123
    s_and_b32 s57, s74, 15
    s_and_b32 s58, s57, 3
    s_lshl_b32 s58, s58, 1
    s_lshr_b32 s59, s57, 3
    s_add_u32 s58, s58, s59
    s_mul_i32 s58, s58, 9216
    s_lshr_b32 s59, s57, 2
    s_and_b32 s59, s59, 1
    s_lshl_b32 s59, s59, 9
    s_add_u32 s58, s58, s59
    s_lshr_b32 s59, s74, 4
    s_lshl_b32 s59, s59, 6
    s_add_u32 s58, s58, s59
    s_mul_i32 s59, s70, 147456
    s_add_u32 s58, s58, s59
    v_add_u32 v123, s58, v123
    v_mov_b32 v124, 2147483632
    v_cmp_gt_u32 vcc, 36, v1
    s_nop 1
    v_cndmask_b32 v123, v124, v123, vcc
    buffer_load_dwordx4 v[148:151], v55, s[28:31], s66 offen
    v_lshlrev_b32 v3, 4, v1
    v_add_u32 v3, s59, v3
    s_mov_b32 s60, 32768
    s_mov_b32 s61, 4096
    s_mov_b32 s62, 8192
    s_mov_b32 s63, 12288
    s_mov_b32 s64, 16384
    s_mov_b32 s76, 262144
    s_mov_b32 s77, 524288
    s_mov_b32 s78, 786432
    s_mov_b32 s79, 528384
    s_mov_b32 s80, 73728
    s_mov_b32 s82, 1.0
    s_mov_b32 s83, 1.0
    s_mov_b32 s84, 0xffff0000
    s_mov_b32 s86, 0xbfb8aa3b
    s_mov_b32 s87, 0xbfb8aa3b
    s_mov_b32 s88, 0xbf317218
    s_mov_b32 s89, 0xbf317218
    buffer_load_dwordx4 v[156:159], v55, s[28:31], s67 offen
    s_mov_b32 s81, 128
    s_cmp_eq_u32 s72, 0
    s_cselect_b32 s68, 0, 1.0
    s_cmp_eq_u32 s72, 124
    s_cselect_b32 s69, 0, 1.0
    s_lshl_b32 s56, s71, 22
    s_lshl_b32 s57, s70, 20
    s_add_u32 s56, s56, s57
    s_lshl_b32 s57, s73, 1
    s_add_u32 s56, s56, s57
    v_bfe_u32 v54, v1, 2, 1
    v_mul_u32_u24 v48, 5, v54
    s_sub_u32 s3, s72, 1
    v_add_u32 v51, s3, v48
    v_mov_b32 v49, 0xbfb8aa3b
    v_cmp_gt_u32 vcc, 0x80, v51
    s_nop 1
    v_cndmask_b32 v116, 0, v49, vcc
    v_max_i32 v51, 0, v51
    v_min_u32 v51, 127, v51
    v_lshrrev_b32 v105, 3, v1
    buffer_load_dwordx4 v[164:167], v56, s[28:31], 0 offen
    v_lshl_add_u32 v57, v50, 4, s56
    v_lshl_add_u32 v57, v51, 8, v57
    v_lshl_add_u32 v57, v105, 17, v57
    s_add_u32 s40, s26, 2097152
    s_addc_u32 s41, s27, 0
    s_mov_b32 s42, 18350080
    s_mov_b32 s43, 0x20000
    s_mov_b32 s44, s22
    s_mov_b32 s45, s23
    s_mov_b32 s46, 8388608
    s_mov_b32 s47, 0x20000
    s_mul_i32 s56, s71, 2304
    s_add_u32 s48, s6, s56
    s_addc_u32 s49, s7, 0
    s_mov_b32 s50, 2304
    s_mov_b32 s51, 0x20000
    s_mov_b32 s52, s14
    s_mov_b32 s53, s15
    s_mov_b32 s54, 294912
    buffer_load_dwordx4 v[172:175], v56, s[28:31], s65 offen
    s_mov_b32 s55, 0x20000
    v_and_b32 v60, 31, v1
    v_lshrrev_b32 v61, 5, v1
    v_mul_u32_u24 v2, 15744, v61
    v_lshl_add_u32 v2, v60, 4, v2
    v_add_u32 v2, 16, v2
    s_mul_i32 s56, s70, 15744
    s_add_u32 s57, s56, 62976
    s_add_u32 s58, s56, 32
    v_lshl_add_u32 v124, v50, 7, s58
    v_mul_u32_u24 v126, 3936, v61
    v_mul_u32_u24 v63, 656, v52
    v_add3_u32 v7, v126, v63, v124
    v_and_b32 v126, 1, v53
    v_lshlrev_b32 v126, 3, v126
    v_add_u32 v126, 656, v126
    v_add_u32 v7, v126, v7
    v_lshrrev_b32 v126, 1, v105
    v_mul_u32_u24 v126, 3936, v126
    v_mul_u32_u24 v63, 656, v48
    buffer_load_dwordx4 v[180:183], v56, s[28:31], s66 offen
    v_add3_u32 v4, v126, v63, v124
    v_and_b32 v126, 1, v105
    v_lshl_add_u32 v4, v126, 3, v4
    v_lshl_add_u32 v125, v50, 4, s57
    v_mul_u32_u24 v126, 1088, v53
    v_lshl_add_u32 v126, v52, 6, v126
    v_add_u32 v100, v126, v125
    s_lshl_b32 s58, s71, 7
    s_add_u32 s58, s58, s74
    s_lshl_b32 s58, s58, 12
    s_lshl_b32 s59, s70, 9
    s_add_u32 s58, s58, s59
    s_add_u32 s58, s58, 16777216
    v_lshrrev_b32 v63, 2, v1
    v_lshl_add_u32 v63, v63, 4, s58
    v_lshrrev_b32 v126, 1, v50
    v_lshl_add_u32 v63, v126, 11, v63
    v_add_u32 v126, 1, v50
    v_and_b32 v126, 2, v126
    v_mov_b32 v124, 2147483632
    buffer_load_dwordx4 v[188:191], v56, s[28:31], s67 offen
    v_cmp_eq_u32 vcc, 0, v126
    s_nop 1
    v_cndmask_b32 v237, v124, v63, vcc
    v_lshl_add_u32 v63, v105, 2, v50
    v_lshl_add_u32 v63, v63, 4, s58
    v_lshl_add_u32 v63, v54, 11, v63
    v_lshlrev_b32 v126, 12, v54
    v_subrev_u32 v126, 2048, v126
    v_add_u32 v126, v63, v126
    s_cmp_eq_u32 s73, 0
    s_cselect_b32 s58, 0, 7
    s_cmp_eq_u32 s73, 96
    s_cselect_b32 s58, 1, s58
    v_cmp_ne_u32 vcc, s58, v54
    s_nop 1
    v_cndmask_b32 v232, v124, v126, vcc
    v_cndmask_b32 v104, 0, v49, vcc
    v_lshrrev_b32 v63, 1, v105
    v_mul_u32_u24 v103, 3936, v63
    v_mul_u32_u24 v63, 528, v54
    v_add3_u32 v103, v103, v63, s56
    v_mul_u32_u24 v63, 656, v50
    v_and_b32 v126, 1, v105
    v_lshl_add_u32 v63, v126, 3, v63
    v_add3_u32 v103, v103, v63, 16
    v_add_u32 v103, 656, v103
    v_cmp_ne_u32 vcc, s58, v61
    s_nop 1
    v_cndmask_b32 v236, 0, v49, vcc
    v_lshrrev_b32 v63, 3, v60
    v_mul_u32_u24 v233, 3936, v63
    v_mul_u32_u24 v63, 528, v61
    v_add3_u32 v233, v233, v63, s56
    v_and_b32 v63, 7, v60
    v_lshl_add_u32 v233, v63, 1, v233
    v_add_u32 v233, 16, v233
    s_lshl_b32 s59, s71, 7
    s_add_u32 s59, s59, s74
    s_lshl_b32 s59, s59, 11
    s_lshl_b32 s3, s70, 9
    s_add_u32 s59, s59, s3
    s_add_u32 s59, s59, 17825792
    v_lshl_add_u32 v63, v105, 4, s59
    v_lshl_add_u32 v63, v54, 7, v63
    v_lshrrev_b32 v126, 1, v50
    v_lshl_add_u32 v63, v126, 8, v63
    s_mov_b32 s90, 0x99999999
    s_mov_b32 s91, 0x99999999
    v_cndmask_b32 v102, v124, v63, s[90:91]
    s_waitcnt vmcnt(10)
    ds_write_b128 v58, v[64:67]
    s_waitcnt vmcnt(9)
    ds_write_b128 v58, v[68:71] offset:640
    ds_read_u16 v72, v59 offset:0
    ds_read_u16 v73, v59 offset:18
    ds_read_u16 v74, v59 offset:36
    ds_read_u16 v75, v59 offset:54
    ds_read_u16 v76, v59 offset:72
    ds_read_u16 v77, v59 offset:90
    ds_read_u16 v78, v59 offset:108
    ds_read_u16 v79, v59 offset:126
    ds_read_u16 v80, v59 offset:640
    ds_read_u16 v81, v59 offset:658
    ds_read_u16 v82, v59 offset:676
    ds_read_u16 v83, v59 offset:694
    ds_read_u16 v84, v59 offset:712
    ds_read_u16 v85, v59 offset:730
    ds_read_u16 v86, v59 offset:748
    ds_read_u16 v87, v59 offset:766
    v_lshrrev_b32 v63, 2, v60
    v_lshl_add_u32 v63, v63, 4, s59
    v_lshl_add_u32 v63, v61, 8, v63
    v_mul_u32_u24 v126, 3584, v61
    v_subrev_u32 v126, 1792, v126
    v_add_u32 v126, v63, v126
    v_cmp_ne_u32 vcc, s58, v61
    s_nop 1
    v_cndmask_b32 v254, v63, v126, vcc
    v_and_b32 v63, 3, v60
    v_mul_u32_u24 v63, 0x202, v63
    v_add_u32 v63, 0x100, v63
    v_lshlrev_b32 v63, 16, v63
    v_or_b32 v255, 0xc0c, v63
    s_lshr_b32 s58, s2, 3
    s_mul_i32 s58, s58, 18432
    s_mul_i32 s59, s70, 4608
    s_add_u32 s58, s58, s59
    v_lshl_add_u32 v46, v1, 7, s58
    v_mov_b32 v63, 2147483632
    v_cmp_gt_u32 vcc, 36, v1
    s_nop 1
    v_cndmask_b32 v46, v63, v46, vcc
    s_waitcnt lgkmcnt(14)
    v_lshl_or_b32 v64, v73, 16, v72
    s_waitcnt lgkmcnt(12)
    v_lshl_or_b32 v65, v75, 16, v74
    s_waitcnt lgkmcnt(10)
    v_lshl_or_b32 v66, v77, 16, v76
    s_waitcnt lgkmcnt(8)
    v_lshl_or_b32 v67, v79, 16, v78
    buffer_store_dwordx4 v[64:67], v123, s[36:39], 0 offen sc1
    s_lshl_b32 s58, s71, 14
    s_add_u32 s58, s58, 4096
    s_lshl_b32 s59, s70, 12
    s_add_u32 s59, s59, s58
    v_lshrrev_b32 v124, 2, v1
    v_and_b32 v125, 3, v1
    v_lshlrev_b32 v124, 7, v124
    v_lshl_add_u32 v124, v125, 4, v124
    v_add_u32 v10, s59, v124
    s_lshl_b32 s59, s70, 4
    s_add_u32 s85, s59, 126528
    s_lshl_b32 s59, s74, 7
    s_add_u32 s58, s58, s59
    s_waitcnt lgkmcnt(6)
    v_lshl_or_b32 v68, v81, 16, v80
    s_waitcnt lgkmcnt(4)
    v_lshl_or_b32 v69, v83, 16, v82
    s_waitcnt lgkmcnt(2)
    v_lshl_or_b32 v70, v85, 16, v84
    s_waitcnt lgkmcnt(0)
    v_lshl_or_b32 v71, v87, 16, v86
    buffer_store_dwordx4 v[68:71], v123, s[36:39], s80 offen sc1
    v_mov_b32 v124, 2147483632
    v_lshl_add_u32 v125, v0, 4, s58
    v_cmp_gt_u32 vcc, 4, v0
    s_nop 1
    v_cndmask_b32 v9, v124, v125, vcc
    v_lshl_add_u32 v125, v0, 4, s58
    v_add_u32 v125, 64, v125
    v_cmp_gt_u32 vcc, 2, v0
    s_nop 1
    v_cndmask_b32 v11, v124, v125, vcc
    v_lshrrev_b32 v125, 4, v1
    v_lshlrev_b32 v125, 3, v125
    v_bfe_u32 v126, v1, 1, 1
    v_lshl_add_u32 v125, v126, 2, v125
    v_bfe_u32 v126, v1, 2, 2
    v_add_u32 v125, v125, v126
    v_lshlrev_b32 v125, 7, v125
    v_and_b32 v126, 1, v1
    v_lshl_add_u32 v125, v126, 4, v125
    s_lshl_b32 s59, s71, 2
    s_add_u32 s59, s59, s70
    s_lshl_b32 s59, s59, 12
    s_add_u32 s59, s59, 4160
    v_add_u32 v12, s59, v125
    s_lshl_b32 s56, s70, 6
    v_and_b32 v110, 15, v1
    v_lshl_add_u32 v110, v110, 2, s56
    global_load_dword v88, v110, s[8:9]
    global_load_dword v89, v110, s[10:11]
    global_load_dword v90, v110, s[16:17]
    global_load_dword v91, v110, s[18:19]
    v_mov_b32 v119, 0x3f803f80
    s_waitcnt vmcnt(13)
    v_dot2_f32_bf16 v64, v132, v119, 0
    v_dot2_f32_bf16 v65, v132, v132, 0
    v_dot2_f32_bf16 v66, v133, v119, 0
    v_dot2_f32_bf16 v67, v133, v133, 0
    v_dot2_f32_bf16 v68, v134, v119, 0
    v_dot2_f32_bf16 v69, v134, v134, 0
    v_dot2_f32_bf16 v70, v135, v119, 0
    v_dot2_f32_bf16 v71, v135, v135, 0
    s_waitcnt vmcnt(12)
    v_dot2_f32_bf16 v64, v140, v119, v64
    v_dot2_f32_bf16 v65, v140, v140, v65
    v_dot2_f32_bf16 v66, v141, v119, v66
    v_dot2_f32_bf16 v67, v141, v141, v67
    v_dot2_f32_bf16 v68, v142, v119, v68
    v_dot2_f32_bf16 v69, v142, v142, v69
    v_dot2_f32_bf16 v70, v143, v119, v70
    v_dot2_f32_bf16 v71, v143, v143, v71
    s_waitcnt vmcnt(11)
    v_dot2_f32_bf16 v64, v148, v119, v64
    v_dot2_f32_bf16 v65, v148, v148, v65
    v_dot2_f32_bf16 v66, v149, v119, v66
    v_dot2_f32_bf16 v67, v149, v149, v67
    v_dot2_f32_bf16 v68, v150, v119, v68
    v_dot2_f32_bf16 v69, v150, v150, v69
    v_dot2_f32_bf16 v70, v151, v119, v70
    v_dot2_f32_bf16 v71, v151, v151, v71
    s_waitcnt vmcnt(10)
    v_dot2_f32_bf16 v64, v156, v119, v64
    v_dot2_f32_bf16 v65, v156, v156, v65
    v_dot2_f32_bf16 v66, v157, v119, v66
    v_dot2_f32_bf16 v67, v157, v157, v67
    v_dot2_f32_bf16 v68, v158, v119, v68
    v_dot2_f32_bf16 v69, v158, v158, v69
    v_dot2_f32_bf16 v70, v159, v119, v70
    v_dot2_f32_bf16 v71, v159, v159, v71
    s_waitcnt vmcnt(9)
    v_dot2_f32_bf16 v64, v164, v119, v64
    v_dot2_f32_bf16 v65, v164, v164, v65
    v_dot2_f32_bf16 v66, v165, v119, v66
    v_dot2_f32_bf16 v67, v165, v165, v67
    v_dot2_f32_bf16 v68, v166, v119, v68
    v_dot2_f32_bf16 v69, v166, v166, v69
    v_dot2_f32_bf16 v70, v167, v119, v70
    v_dot2_f32_bf16 v71, v167, v167, v71
    s_waitcnt vmcnt(8)
    v_dot2_f32_bf16 v64, v172, v119, v64
    v_dot2_f32_bf16 v65, v172, v172, v65
    v_dot2_f32_bf16 v66, v173, v119, v66
    v_dot2_f32_bf16 v67, v173, v173, v67
    v_dot2_f32_bf16 v68, v174, v119, v68
    v_dot2_f32_bf16 v69, v174, v174, v69
    v_dot2_f32_bf16 v70, v175, v119, v70
    v_dot2_f32_bf16 v71, v175, v175, v71
    s_waitcnt vmcnt(7)
    v_dot2_f32_bf16 v64, v180, v119, v64
    v_dot2_f32_bf16 v65, v180, v180, v65
    v_dot2_f32_bf16 v66, v181, v119, v66
    v_dot2_f32_bf16 v67, v181, v181, v67
    v_dot2_f32_bf16 v68, v182, v119, v68
    v_dot2_f32_bf16 v69, v182, v182, v69
    v_dot2_f32_bf16 v70, v183, v119, v70
    v_dot2_f32_bf16 v71, v183, v183, v71
    s_waitcnt vmcnt(6)
    v_dot2_f32_bf16 v64, v188, v119, v64
    v_dot2_f32_bf16 v65, v188, v188, v65
    v_dot2_f32_bf16 v66, v189, v119, v66
    v_dot2_f32_bf16 v67, v189, v189, v67
    v_dot2_f32_bf16 v68, v190, v119, v68
    v_dot2_f32_bf16 v69, v190, v190, v69
    v_dot2_f32_bf16 v70, v191, v119, v70
    v_dot2_f32_bf16 v71, v191, v191, v71
    s_mov_b32 s56, 0x9E3779B1
    v_mul_lo_u32 v8, v8, s56
    v_add_f32 v64, v64, v66
    v_add_f32 v65, v65, v67
    v_add_f32 v68, v68, v70
    v_add_f32 v69, v69, v71
    v_add_u32 v8, 0x7F4A7C15, v8
    v_add_f32 v26, v64, v68
    v_add_f32 v28, v65, v69
    v_mov_b32 v27, v8
    v_add_f32_dpp v26, v26, v26 row_ror:8 row_mask:0xf bank_mask:0xf
    v_add_f32_dpp v28, v28, v28 row_ror:8 row_mask:0xf bank_mask:0xf
    v_mov_b32 v29, v8
    v_add_f32_dpp v26, v26, v26 row_ror:4 row_mask:0xf bank_mask:0xf
    v_add_f32_dpp v28, v28, v28 row_ror:4 row_mask:0xf bank_mask:0xf
    v_mov_b32 v61, s85
    v_add_f32_dpp v26, v26, v26 row_ror:2 row_mask:0xf bank_mask:0xf
    v_add_f32_dpp v28, v28, v28 row_ror:2 row_mask:0xf bank_mask:0xf
    v_and_b32 v60, 3, v1
    v_add_f32_dpp v26, v26, v26 row_ror:1 row_mask:0xf bank_mask:0xf
    v_add_f32_dpp v28, v28, v28 row_ror:1 row_mask:0xf bank_mask:0xf
    v_lshlrev_b32 v60, 4, v60
    v_add_f32_dpp v26, v26, v26 row_bcast:15 row_mask:0xa bank_mask:0xf
    v_add_f32_dpp v28, v28, v28 row_bcast:15 row_mask:0xa bank_mask:0xf
    v_add_u32 v60, 126528, v60
    v_add_f32_dpp v26, v26, v26 row_bcast:31 row_mask:0xc bank_mask:0xf
    v_add_f32_dpp v28, v28, v28 row_bcast:31 row_mask:0xc bank_mask:0xf
    s_mov_b32 exec_lo, 0
    s_mov_b32 exec_hi, 0x10000
    ds_write_b128 v61, v[26:29]
    s_mov_b64 exec, -1
    s_waitcnt vmcnt(4) lgkmcnt(0)
    s_barrier
    ds_read_b128 v[124:127], v60
    s_waitcnt lgkmcnt(0)
    buffer_store_dwordx4 v[124:127], v9, s[32:35], 0 offen sc1
    s_mov_b32 s90, 0x88888888
    s_mov_b32 s91, 0x88888888
    v_mov_b32 v72, 0x05040100
    v_mov_b32 v73, 0x07060302
    v_cndmask_b32 v72, v72, v73, s[90:91]
    v_cndmask_b32 v106, v132, v135, s[90:91]
    v_cndmask_b32 v107, v140, v143, s[90:91]
    v_cndmask_b32 v108, v148, v151, s[90:91]
    v_cndmask_b32 v109, v156, v159, s[90:91]
    v_perm_b32 v224, v107, v106, v72
    v_perm_b32 v225, v109, v108, v72
    v_mov_b32 v226, v8
    buffer_store_dwordx3 v[224:226], v237, s[40:43], 0 offen offset:0 sc1
    v_cndmask_b32 v106, v164, v167, s[90:91]
    v_cndmask_b32 v107, v172, v175, s[90:91]
    v_cndmask_b32 v108, v180, v183, s[90:91]
    v_cndmask_b32 v109, v188, v191, s[90:91]
    v_perm_b32 v120, v107, v106, v72
    v_perm_b32 v121, v109, v108, v72
    v_mov_b32 v122, v8
    buffer_store_dwordx3 v[120:122], v237, s[40:43], 0 offen offset:256 sc1
    s_lshl_b32 s56, s70, 8
    s_add_u32 s56, s56, 126976
    v_and_b32 v110, 15, v1
    v_lshl_add_u32 v110, v110, 2, s56
    s_mov_b64 exec, 0xffff
    s_waitcnt vmcnt(6)
    ds_write_b32 v110, v88 offset:0
    s_waitcnt vmcnt(5)
    ds_write_b32 v110, v89 offset:64
    s_waitcnt vmcnt(4)
    ds_write_b32 v110, v90 offset:128
    s_waitcnt vmcnt(3)
    ds_write_b32 v110, v91 offset:192
    s_mov_b64 exec, -1
    v_lshrrev_b32 v110, 4, v1
    v_lshrrev_b32 v111, 3, v1
    v_and_b32 v112, 31, v1
    v_lshl_add_u32 v110, v110, 3, s56
    v_lshl_add_u32 v111, v111, 3, s56
    v_lshl_add_u32 v112, v112, 1, s56
    ds_read_b64 v[88:89], v110 offset:0
    ds_read_b64 v[94:95], v110 offset:64
    ds_read_b64 v[90:91], v110 offset:32
    ds_read_b64 v[96:97], v110 offset:96
    ds_read_b64 v[92:93], v111 offset:0
    ds_read_b64 v[98:99], v111 offset:64
    ds_read_u16 v234, v112
    ds_read_u16 v235, v112 offset:64
    s_waitcnt lgkmcnt(7)
    v_lshlrev_b32 v76, 16, v88
    v_and_b32 v77, s84, v88
    s_waitcnt lgkmcnt(6)
    v_lshlrev_b32 v32, 16, v94
    v_and_b32 v33, s84, v94
    v_lshlrev_b32 v78, 16, v89
    v_and_b32 v79, s84, v89
    v_lshlrev_b32 v34, 16, v95
    v_and_b32 v35, s84, v95
    s_waitcnt lgkmcnt(5)
    v_lshlrev_b32 v80, 16, v90
    v_and_b32 v81, s84, v90
    s_waitcnt lgkmcnt(4)
    v_lshlrev_b32 v36, 16, v96
    v_and_b32 v37, s84, v96
    v_lshlrev_b32 v82, 16, v91
    v_and_b32 v83, s84, v91
    v_lshlrev_b32 v38, 16, v97
    v_and_b32 v39, s84, v97
    s_waitcnt lgkmcnt(3)
    v_lshlrev_b32 v84, 16, v92
    v_and_b32 v85, s84, v92
    s_waitcnt lgkmcnt(2)
    v_lshlrev_b32 v40, 16, v98
    v_and_b32 v41, s84, v98
    v_lshlrev_b32 v86, 16, v93
    v_and_b32 v87, s84, v93
    v_lshlrev_b32 v42, 16, v99
    v_and_b32 v43, s84, v99
    v_mul_f32 v64, v84, v104
    v_mul_f32 v65, v85, v104
    v_mul_f32 v66, v86, v104
    v_mul_f32 v67, v87, v104
    v_mul_f32 v68, v40, v104
    v_mul_f32 v69, v41, v104
    v_mul_f32 v70, v42, v104
    v_mul_f32 v71, v43, v104
    v_mul_f32 v32, s86, v32
    v_mul_f32 v33, s86, v33
    v_mul_f32 v34, s86, v34
    v_mul_f32 v35, s86, v35
    v_mul_f32 v36, s86, v36
    v_mul_f32 v37, s86, v37
    v_mul_f32 v38, s86, v38
    v_mul_f32 v39, s86, v39
    v_mul_f32 v40, v40, v116
    v_mul_f32 v41, v41, v116
    v_mul_f32 v42, v42, v116
    v_mul_f32 v43, v43, v116
    s_waitcnt lgkmcnt(1)
    v_lshlrev_b32 v234, 16, v234
    s_waitcnt lgkmcnt(0)
    v_lshlrev_b32 v235, 16, v235
    v_mul_f32 v235, v235, v236
    ds_write_b128 v100, v[132:135] offset:0
    ds_write_b128 v100, v[140:143] offset:272
    ds_write_b128 v100, v[148:151] offset:544
    ds_write_b128 v100, v[156:159] offset:816
    v_and_b32 v120, 0xffff, v88
    v_lshrrev_b32 v121, 16, v88
    v_and_b32 v122, 0xffff, v89
    v_lshrrev_b32 v123, 16, v89
    v_dot2_f32_bf16 v128, v132, v120, 0
    v_dot2_f32_bf16 v129, v132, v76, 0
    v_dot2_f32_bf16 v130, v133, v120, 0
    v_dot2_f32_bf16 v131, v133, v76, 0
    v_dot2_f32_bf16 v132, v134, v120, 0
    v_dot2_f32_bf16 v133, v134, v76, 0
    v_dot2_f32_bf16 v134, v135, v120, 0
    v_dot2_f32_bf16 v135, v135, v76, 0
    v_dot2_f32_bf16 v136, v140, v121, 0
    v_dot2_f32_bf16 v137, v140, v77, 0
    v_dot2_f32_bf16 v138, v141, v121, 0
    v_dot2_f32_bf16 v139, v141, v77, 0
    v_dot2_f32_bf16 v140, v142, v121, 0
    v_dot2_f32_bf16 v141, v142, v77, 0
    v_dot2_f32_bf16 v142, v143, v121, 0
    v_dot2_f32_bf16 v143, v143, v77, 0
    v_dot2_f32_bf16 v144, v148, v122, 0
    v_dot2_f32_bf16 v145, v148, v78, 0
    v_dot2_f32_bf16 v146, v149, v122, 0
    v_dot2_f32_bf16 v147, v149, v78, 0
    v_dot2_f32_bf16 v148, v150, v122, 0
    v_dot2_f32_bf16 v149, v150, v78, 0
    v_dot2_f32_bf16 v150, v151, v122, 0
    v_dot2_f32_bf16 v151, v151, v78, 0
    v_dot2_f32_bf16 v152, v156, v123, 0
    v_dot2_f32_bf16 v153, v156, v79, 0
    v_dot2_f32_bf16 v154, v157, v123, 0
    v_dot2_f32_bf16 v155, v157, v79, 0
    v_dot2_f32_bf16 v156, v158, v123, 0
    v_dot2_f32_bf16 v157, v158, v79, 0
    v_dot2_f32_bf16 v158, v159, v123, 0
    v_dot2_f32_bf16 v159, v159, v79, 0
    ds_write_b128 v100, v[164:167] offset:4352
    ds_write_b128 v100, v[172:175] offset:4624
    ds_write_b128 v100, v[180:183] offset:4896
    ds_write_b128 v100, v[188:191] offset:5168
    buffer_load_dwordx4 v[48:51], v10, s[32:35], 0 offen sc1
    buffer_load_dwordx4 v[52:55], v10, s[32:35], 0 offen offset:2048 sc1
    buffer_load_dwordx3 v[228:230], v232, s[40:43], 0 offen sc1
    v_and_b32 v120, 0xffff, v90
    v_lshrrev_b32 v121, 16, v90
    v_and_b32 v122, 0xffff, v91
    v_lshrrev_b32 v123, 16, v91
    v_dot2_f32_bf16 v160, v164, v120, 0
    v_dot2_f32_bf16 v161, v164, v80, 0
    v_dot2_f32_bf16 v162, v165, v120, 0
    v_dot2_f32_bf16 v163, v165, v80, 0
    v_dot2_f32_bf16 v164, v166, v120, 0
    v_dot2_f32_bf16 v165, v166, v80, 0
    v_dot2_f32_bf16 v166, v167, v120, 0
    v_dot2_f32_bf16 v167, v167, v80, 0
    v_dot2_f32_bf16 v168, v172, v121, 0
    v_dot2_f32_bf16 v169, v172, v81, 0
    v_dot2_f32_bf16 v170, v173, v121, 0
    v_dot2_f32_bf16 v171, v173, v81, 0
    v_dot2_f32_bf16 v172, v174, v121, 0
    v_dot2_f32_bf16 v173, v174, v81, 0
    v_dot2_f32_bf16 v174, v175, v121, 0
    v_dot2_f32_bf16 v175, v175, v81, 0
    v_dot2_f32_bf16 v176, v180, v122, 0
    v_dot2_f32_bf16 v177, v180, v82, 0
    v_dot2_f32_bf16 v178, v181, v122, 0
    v_dot2_f32_bf16 v179, v181, v82, 0
    v_dot2_f32_bf16 v180, v182, v122, 0
    v_dot2_f32_bf16 v181, v182, v82, 0
    v_dot2_f32_bf16 v182, v183, v122, 0
    v_dot2_f32_bf16 v183, v183, v82, 0
    v_dot2_f32_bf16 v184, v188, v123, 0
    v_dot2_f32_bf16 v185, v188, v83, 0
    v_dot2_f32_bf16 v186, v189, v123, 0
    v_dot2_f32_bf16 v187, v189, v83, 0
    v_dot2_f32_bf16 v188, v190, v123, 0
    v_dot2_f32_bf16 v189, v190, v83, 0
    v_dot2_f32_bf16 v190, v191, v123, 0
    v_dot2_f32_bf16 v191, v191, v83, 0
    buffer_load_dwordx4 v[196:199], v57, s[28:31], 0 offen
    buffer_load_dwordx4 v[204:207], v57, s[28:31], s65 offen
    buffer_load_dwordx4 v[212:215], v57, s[28:31], s66 offen
    buffer_load_dwordx4 v[220:223], v57, s[28:31], s67 offen
    s_and_b32 s56, s74, 3
    s_mul_i32 s56, s56, 288
    v_add_u32 v113, s56, v0
    v_lshlrev_b32 v115, 8, v113
    s_lshr_b32 s57, s74, 2
    s_lshl_b32 s57, s57, 3
    v_add_u32 v115, s57, v115
    v_lshlrev_b32 v113, 1, v113
    v_mov_b32 v60, 2147483632
    v_cmp_gt_u32 vcc, 32, v0
    v_add_u32 v114, 512, v113
    v_add_u32 v117, 65536, v115
    v_cndmask_b32 v114, v60, v114, vcc
    v_cndmask_b32 v117, v60, v117, vcc
    s_lshl_b32 s56, s70, 5
    s_add_u32 s56, s56, 128000
    v_and_b32 v88, 3, v1
    v_mul_u32_u24 v88, 160, v88
    v_lshrrev_b32 v89, 4, v1
    v_lshl_add_u32 v88, v89, 3, v88
    v_add_u32 v88, s56, v88
    s_mul_i32 s56, s70, 160
    s_add_u32 s56, s56, 128000
    v_and_b32 v89, 15, v1
    v_lshl_add_u32 v89, v89, 3, s56
    s_lshl_b32 s56, s71, 7
    s_add_u32 s56, s56, s74
    s_lshl_b32 s56, s56, 7
    s_add_u32 s56, s56, 4096
    v_and_b32 v62, 3, v1
    v_lshl_add_u32 v62, v62, 4, s56
    v_sub_u32 v62, v62, v10
    v_cmp_eq_u32 s[90:91], 0, v62
    v_cmp_eq_u32 vcc, 2048, v62
    v_cmp_eq_u32 s[96:97], 0, v104
    s_waitcnt vmcnt(4)
    s_mov_b64 exec, s[90:91]
    v_mov_b64 v[48:49], v[124:125]
    v_mov_b64 v[50:51], v[126:127]
    s_mov_b64 exec, vcc
    v_mov_b64 v[52:53], v[124:125]
    v_mov_b64 v[54:55], v[126:127]
    s_mov_b64 exec, -1
    s_mov_b64 exec, s[96:97]
    v_mov_b32 v230, v8
    s_mov_b64 exec, -1
    v_xor_b32 v60, v8, v49
    v_xor_b32 v61, v8, v51
    v_xor_b32 v62, v8, v53
    v_xor_b32 v63, v8, v55
    v_or3_b32 v60, v60, v61, v62
    v_xor_b32 v61, v8, v230
    v_or3_b32 v60, v60, v61, v63
    v_cmp_ne_u32 vcc, 0, v60
    s_cbranch_vccz L_p1_ok
    s_mov_b32 s75, 0x4000
L_p1_re:
    v_xor_b32 v60, v8, v49
    v_xor_b32 v61, v8, v51
    v_or_b32 v60, v60, v61
    v_cmp_ne_u32 s[90:91], 0, v60
    v_xor_b32 v60, v8, v53
    v_xor_b32 v61, v8, v55
    v_or_b32 v60, v60, v61
    v_cmp_ne_u32 s[96:97], 0, v60
    v_xor_b32 v60, v8, v230
    v_cmp_ne_u32 s[56:57], 0, v60
    s_nop 3
    s_or_b64 s[58:59], s[90:91], s[96:97]
    s_or_b64 s[58:59], s[58:59], s[56:57]
    s_cbranch_scc0 L_p1_ok
    s_sub_u32 s75, s75, 1
    s_cbranch_scc1 L_p1_ok
    s_mov_b64 exec, s[90:91]
    buffer_load_dwordx4 v[48:51], v10, s[32:35], 0 offen sc1
    s_mov_b64 exec, s[96:97]
    buffer_load_dwordx4 v[52:55], v10, s[32:35], 0 offen offset:2048 sc1
    s_mov_b64 exec, s[56:57]
    buffer_load_dwordx3 v[228:230], v232, s[40:43], 0 offen sc1
    s_mov_b64 exec, -1
    s_waitcnt vmcnt(0)
    s_branch L_p1_re
L_p1_ok:
    buffer_load_dword v47, v46, s[36:39], 0 offen sc1
    v_add_f32 v48, v48, v52
    v_add_f32 v49, v50, v54
    s_nop 0
    v_add_f32_dpp v48, v48, v48 row_ror:8 row_mask:0xf bank_mask:0xf
    v_add_f32_dpp v49, v49, v49 row_ror:8 row_mask:0xf bank_mask:0xf
    s_nop 0
    v_add_f32_dpp v48, v48, v48 row_ror:4 row_mask:0xf bank_mask:0xf
    v_add_f32_dpp v49, v49, v49 row_ror:4 row_mask:0xf bank_mask:0xf
    s_mov_b32 exec_lo, 0x000f000f
    s_mov_b32 exec_hi, 0x000f000f
    ds_write_b64 v88, v[48:49]
    s_mov_b64 exec, -1
    v_lshlrev_b32 v238, 16, v228
    v_and_b32 v239, s84, v228
    v_lshlrev_b32 v240, 16, v229
    v_and_b32 v241, s84, v229
    s_waitcnt lgkmcnt(0)
    s_barrier
    ds_read_b64 v[48:49], v89
    s_waitcnt lgkmcnt(0)
    v_add_f32_dpp v48, v48, v48 row_ror:8 row_mask:0xf bank_mask:0xf
    v_add_f32_dpp v49, v49, v49 row_ror:8 row_mask:0xf bank_mask:0xf
    s_nop 0
    v_add_f32_dpp v48, v48, v48 row_ror:4 row_mask:0xf bank_mask:0xf
    v_add_f32_dpp v49, v49, v49 row_ror:4 row_mask:0xf bank_mask:0xf
    s_nop 0
    v_add_f32_dpp v48, v48, v48 row_ror:2 row_mask:0xf bank_mask:0xf
    v_add_f32_dpp v49, v49, v49 row_ror:2 row_mask:0xf bank_mask:0xf
    s_nop 0
    v_add_f32_dpp v48, v48, v48 row_ror:1 row_mask:0xf bank_mask:0xf
    v_add_f32_dpp v50, v49, v49 row_ror:1 row_mask:0xf bank_mask:0xf
    v_mul_f32 v60, 0x36000000, v48
    v_mul_f32 v61, 0x36000000, v50
    v_fma_f32 v61, -v60, v60, v61
    v_max_f32 v61, 0, v61
    v_add_f32 v61, 0x3727c5ac, v61
    v_rsq_f32 v61, v61
    s_nop 0
    v_mul_f32 v6, s86, v61
    v_mul_f32 v64, v61, v64
    v_mul_f32 v65, v61, v65
    v_mul_f32 v66, v61, v66
    v_mul_f32 v67, v61, v67
    v_mul_f32_e64 v120, -v60, v6
    v_fma_f32 v68, -v60, v64, v68
    v_fma_f32 v69, -v60, v65, v69
    v_fma_f32 v70, -v60, v66, v70
    v_fma_f32 v71, -v60, v67, v71
    v_fma_f32 v32, v120, v76, v32
    v_fma_f32 v33, v120, v77, v33
    v_fma_f32 v34, v120, v78, v34
    v_fma_f32 v35, v120, v79, v35
    buffer_load_ushort a120, v113, s[48:51], 0 offen
    v_fma_f32 v238, v238, v64, v68
    v_fma_f32 v239, v239, v65, v69
    v_fma_f32 v240, v240, v66, v70
    v_fma_f32 v241, v241, v67, v71
    v_exp_f32 v48, v238
    buffer_load_ushort a121, v114, s[48:51], 0 offen
    v_exp_f32 v49, v239
    v_exp_f32 v50, v240
    v_exp_f32 v51, v241
    v_pk_add_f32 v[48:49], v[48:49], s[82:83]
    v_pk_add_f32 v[50:51], v[50:51], s[82:83]
    buffer_load_dwordx2 a[122:123], v115, s[52:55], 0 offen
    v_rcp_f32 v48, v48
    v_rcp_f32 v49, v49
    v_rcp_f32 v50, v50
    v_rcp_f32 v51, v51
    v_pk_mul_f32 v[238:239], v[238:239], v[48:49]
    buffer_load_dwordx2 a[124:125], v117, s[52:55], 0 offen
    v_pk_mul_f32 v[240:241], v[240:241], v[50:51]
    v_cvt_pk_bf16_f32 v56, v238, v239
    v_cvt_pk_bf16_f32 v57, v240, v241
    ds_write_b64 v103, v[56:57]
    v_pk_fma_f32 v[128:129], v[128:129], v[6:7], v[32:33] op_sel:[0,0,0] op_sel_hi:[1,0,0]
    v_pk_fma_f32 v[136:137], v[136:137], v[6:7], v[32:33] op_sel:[0,0,1] op_sel_hi:[1,0,1]
    v_pk_fma_f32 v[144:145], v[144:145], v[6:7], v[34:35] op_sel:[0,0,0] op_sel_hi:[1,0,0]
    v_pk_fma_f32 v[152:153], v[152:153], v[6:7], v[34:35] op_sel:[0,0,1] op_sel_hi:[1,0,1]
    v_exp_f32 v48, v128
    v_exp_f32 v49, v129
    v_exp_f32 v50, v136
    v_exp_f32 v51, v137
    v_exp_f32 v52, v144
    v_exp_f32 v53, v145
    v_exp_f32 v54, v152
    v_exp_f32 v55, v153
    v_pk_add_f32 v[48:49], v[48:49], s[82:83]
    v_pk_add_f32 v[50:51], v[50:51], s[82:83]
    v_pk_add_f32 v[52:53], v[52:53], s[82:83]
    v_pk_add_f32 v[54:55], v[54:55], s[82:83]
    v_rcp_f32 v48, v48
    v_rcp_f32 v49, v49
    v_rcp_f32 v50, v50
    v_rcp_f32 v51, v51
    v_rcp_f32 v52, v52
    v_rcp_f32 v53, v53
    v_rcp_f32 v54, v54
    v_rcp_f32 v55, v55
    v_pk_mul_f32 v[128:129], v[128:129], v[48:49]
    v_pk_mul_f32 v[136:137], v[136:137], v[50:51]
    v_pk_mul_f32 v[144:145], v[144:145], v[52:53]
    v_pk_mul_f32 v[152:153], v[152:153], v[54:55]
    v_cvt_pk_bf16_f32 v56, v128, v136
    v_cvt_pk_bf16_f32 v57, v144, v152
    v_cvt_pk_bf16_f32 v58, v129, v137
    v_cvt_pk_bf16_f32 v59, v145, v153
    ds_write_b64 v7, v[56:57] offset:0
    ds_write_b64 v7, v[58:59] offset:16
    v_pk_fma_f32 v[130:131], v[130:131], v[6:7], v[32:33] op_sel:[0,0,0] op_sel_hi:[1,0,0]
    v_pk_fma_f32 v[138:139], v[138:139], v[6:7], v[32:33] op_sel:[0,0,1] op_sel_hi:[1,0,1]
    v_pk_fma_f32 v[146:147], v[146:147], v[6:7], v[34:35] op_sel:[0,0,0] op_sel_hi:[1,0,0]
    v_pk_fma_f32 v[154:155], v[154:155], v[6:7], v[34:35] op_sel:[0,0,1] op_sel_hi:[1,0,1]
    v_exp_f32 v48, v130
    v_exp_f32 v49, v131
    v_exp_f32 v50, v138
    v_exp_f32 v51, v139
    v_exp_f32 v52, v146
    v_exp_f32 v53, v147
    v_exp_f32 v54, v154
    v_exp_f32 v55, v155
    v_pk_add_f32 v[48:49], v[48:49], s[82:83]
    v_pk_add_f32 v[50:51], v[50:51], s[82:83]
    v_pk_add_f32 v[52:53], v[52:53], s[82:83]
    v_pk_add_f32 v[54:55], v[54:55], s[82:83]
    v_rcp_f32 v48, v48
    v_rcp_f32 v49, v49
    v_rcp_f32 v50, v50
    v_rcp_f32 v51, v51
    v_rcp_f32 v52, v52
    v_rcp_f32 v53, v53
    v_rcp_f32 v54, v54
    v_rcp_f32 v55, v55
    buffer_load_dwordx4 a[0:3], v3, s[36:39], 0 offen offset:0 sc1
    v_pk_mul_f32 v[130:131], v[130:131], v[48:49]
    v_pk_mul_f32 v[138:139], v[138:139], v[50:51]
    v_pk_mul_f32 v[146:147], v[146:147], v[52:53]
    v_pk_mul_f32 v[154:155], v[154:155], v[54:55]
    v_cvt_pk_bf16_f32 v56, v130, v138
    v_cvt_pk_bf16_f32 v57, v146, v154
    v_cvt_pk_bf16_f32 v58, v131, v139
    v_cvt_pk_bf16_f32 v59, v147, v155
    ds_write_b64 v7, v[56:57] offset:32
    ds_write_b64 v7, v[58:59] offset:48
    v_pk_fma_f32 v[132:133], v[132:133], v[6:7], v[32:33] op_sel:[0,0,0] op_sel_hi:[1,0,0]
    v_pk_fma_f32 v[140:141], v[140:141], v[6:7], v[32:33] op_sel:[0,0,1] op_sel_hi:[1,0,1]
    buffer_load_dwordx4 a[4:7], v3, s[36:39], 0 offen offset:1024 sc1
    v_pk_fma_f32 v[148:149], v[148:149], v[6:7], v[34:35] op_sel:[0,0,0] op_sel_hi:[1,0,0]
    v_pk_fma_f32 v[156:157], v[156:157], v[6:7], v[34:35] op_sel:[0,0,1] op_sel_hi:[1,0,1]
    v_exp_f32 v48, v132
    v_exp_f32 v49, v133
    v_exp_f32 v50, v140
    v_exp_f32 v51, v141
    v_exp_f32 v52, v148
    v_exp_f32 v53, v149
    v_exp_f32 v54, v156
    v_exp_f32 v55, v157
    v_pk_add_f32 v[48:49], v[48:49], s[82:83]
    v_pk_add_f32 v[50:51], v[50:51], s[82:83]
    v_pk_add_f32 v[52:53], v[52:53], s[82:83]
    buffer_load_dwordx4 a[8:11], v3, s[36:39], 0 offen offset:2048 sc1
    v_pk_add_f32 v[54:55], v[54:55], s[82:83]
    v_rcp_f32 v48, v48
    v_rcp_f32 v49, v49
    v_rcp_f32 v50, v50
    v_rcp_f32 v51, v51
    v_rcp_f32 v52, v52
    v_rcp_f32 v53, v53
    v_rcp_f32 v54, v54
    v_rcp_f32 v55, v55
    v_pk_mul_f32 v[132:133], v[132:133], v[48:49]
    v_pk_mul_f32 v[140:141], v[140:141], v[50:51]
    v_pk_mul_f32 v[148:149], v[148:149], v[52:53]
    buffer_load_dwordx4 a[12:15], v3, s[36:39], 0 offen offset:3072 sc1
    v_pk_mul_f32 v[156:157], v[156:157], v[54:55]
    v_cvt_pk_bf16_f32 v56, v132, v140
    v_cvt_pk_bf16_f32 v57, v148, v156
    v_cvt_pk_bf16_f32 v58, v133, v141
    v_cvt_pk_bf16_f32 v59, v149, v157
    ds_write_b64 v7, v[56:57] offset:64
    ds_write_b64 v7, v[58:59] offset:80
    v_pk_fma_f32 v[134:135], v[134:135], v[6:7], v[32:33] op_sel:[0,0,0] op_sel_hi:[1,0,0]
    v_pk_fma_f32 v[142:143], v[142:143], v[6:7], v[32:33] op_sel:[0,0,1] op_sel_hi:[1,0,1]
    v_pk_fma_f32 v[150:151], v[150:151], v[6:7], v[34:35] op_sel:[0,0,0] op_sel_hi:[1,0,0]
    v_pk_fma_f32 v[158:159], v[158:159], v[6:7], v[34:35] op_sel:[0,0,1] op_sel_hi:[1,0,1]
    v_exp_f32 v48, v134
    v_exp_f32 v49, v135
    buffer_load_dwordx4 a[16:19], v3, s[36:39], s61 offen offset:0 sc1
    v_exp_f32 v50, v142
    v_exp_f32 v51, v143
    v_exp_f32 v52, v150
    v_exp_f32 v53, v151
    v_exp_f32 v54, v158
    v_exp_f32 v55, v159
    v_pk_add_f32 v[48:49], v[48:49], s[82:83]
    v_pk_add_f32 v[50:51], v[50:51], s[82:83]
    v_pk_add_f32 v[52:53], v[52:53], s[82:83]
    v_pk_add_f32 v[54:55], v[54:55], s[82:83]
    v_rcp_f32 v48, v48
    v_rcp_f32 v49, v49
    buffer_load_dwordx4 a[20:23], v3, s[36:39], s61 offen offset:1024 sc1
    v_rcp_f32 v50, v50
    v_rcp_f32 v51, v51
    v_rcp_f32 v52, v52
    v_rcp_f32 v53, v53
    v_rcp_f32 v54, v54
    v_rcp_f32 v55, v55
    v_pk_mul_f32 v[134:135], v[134:135], v[48:49]
    v_pk_mul_f32 v[142:143], v[142:143], v[50:51]
    v_pk_mul_f32 v[150:151], v[150:151], v[52:53]
    v_pk_mul_f32 v[158:159], v[158:159], v[54:55]
    v_cvt_pk_bf16_f32 v56, v134, v142
    v_cvt_pk_bf16_f32 v57, v150, v158
    v_cvt_pk_bf16_f32 v58, v135, v143
    v_cvt_pk_bf16_f32 v59, v151, v159
    ds_write_b64 v7, v[56:57] offset:96
    ds_write_b64 v7, v[58:59] offset:112
    v_mul_f32 v122, v61, v116
    v_mul_f32 v244, v61, v236
    v_mul_f32_e64 v121, -v60, v122
    v_mul_f32 v244, v244, v234
    v_fma_f32 v36, v120, v80, v36
    v_fma_f32 v37, v120, v81, v37
    v_fma_f32 v38, v120, v82, v38
    v_fma_f32 v39, v120, v83, v39
    v_fma_f32 v40, v121, v84, v40
    v_fma_f32 v41, v121, v85, v41
    v_fma_f32 v42, v121, v86, v42
    v_fma_f32 v43, v121, v87, v43
    v_mul_f32 v250, v122, v84
    v_mul_f32 v251, v122, v85
    v_mul_f32 v252, v122, v86
    v_mul_f32 v253, v122, v87
    v_fma_f32 v245, -v60, v244, v235
    v_mul_f32 v246, s68, v244
    v_mul_f32 v247, s68, v245
    v_mul_f32 v248, s69, v244
    v_mul_f32 v249, s69, v245
    s_mov_b32 s90, 0x88888888
    s_mov_b32 s91, 0x88888888
    s_waitcnt vmcnt(14)
    v_cndmask_b32 v106, v196, v199, s[90:91]
    s_waitcnt vmcnt(13)
    v_cndmask_b32 v107, v204, v207, s[90:91]
    s_waitcnt vmcnt(12)
    v_cndmask_b32 v108, v212, v215, s[90:91]
    s_waitcnt vmcnt(11)
    v_cndmask_b32 v109, v220, v223, s[90:91]
    v_perm_b32 v110, v107, v106, v72
    v_perm_b32 v111, v109, v108, v72
    v_mov_b32 v112, v8
    buffer_store_dwordx3 v[110:112], v102, s[40:43], 0 offen sc1
    s_waitcnt lgkmcnt(0)
    s_barrier
    v_add_u32 v150, 18432, v3
    s_waitcnt lgkmcnt(0)
    ds_read_b128 a[72:75], v2 offset:656
    ds_read_b128 a[76:79], v2 offset:1312
    ds_read_b128 a[80:83], v2 offset:1968
    ds_read_b128 a[84:87], v2 offset:2624
    s_waitcnt vmcnt(3) lgkmcnt(1)
    v_mfma_f32_32x32x16_bf16 v[80:95], a[0:3], a[72:75], 0
    buffer_load_dwordx4 a[24:27], v3, s[36:39], s61 offen offset:2048 sc1
    v_lshlrev_b32 v192, 16, v196
    v_and_b32 v193, s84, v196
    v_lshlrev_b32 v200, 16, v204
    v_mfma_f32_32x32x16_bf16 v[96:111], a[0:3], a[76:79], 0
    v_and_b32 v201, s84, v204
    v_lshlrev_b32 v208, 16, v212
    v_and_b32 v209, s84, v212
    v_lshlrev_b32 v216, 16, v220
    v_mfma_f32_32x32x16_bf16 v[112:127], a[0:3], a[80:83], 0
    ds_read_b128 a[88:91], v2 offset:672
    v_and_b32 v217, s84, v220
    v_fma_f32 v192, v192, v250, v40
    v_fma_f32 v193, v193, v250, v40
    v_fma_f32 v200, v200, v251, v41
    v_mfma_f32_32x32x16_bf16 v[64:79], a[4:7], a[72:75], 0
    ds_read_b128 a[92:95], v2 offset:1328
    buffer_load_dwordx4 a[28:31], v3, s[36:39], s61 offen offset:3072 sc1
    v_fma_f32 v201, v201, v251, v41
    v_fma_f32 v208, v208, v252, v42
    v_mfma_f32_32x32x16_bf16 v[80:95], a[4:7], a[76:79], v[80:95]
    ds_read_b128 a[96:99], v2 offset:1984
    v_fma_f32 v209, v209, v252, v42
    v_fma_f32 v216, v216, v253, v43
    v_fma_f32 v217, v217, v253, v43
    v_exp_f32 v48, v192
    v_mfma_f32_32x32x16_bf16 v[96:111], a[4:7], a[80:83], v[96:111]
    v_exp_f32 v49, v193
    v_exp_f32 v50, v200
    v_exp_f32 v51, v201
    s_waitcnt vmcnt(3) lgkmcnt(2)
    v_mfma_f32_32x32x16_bf16 v[112:127], a[4:7], a[84:87], v[112:127]
    buffer_load_dwordx4 a[32:35], v3, s[36:39], s62 offen offset:0 sc1
    v_exp_f32 v52, v208
    v_exp_f32 v53, v209
    v_exp_f32 v54, v216
    v_mfma_f32_32x32x16_bf16 v[64:79], a[8:11], a[76:79], v[64:79]
    v_exp_f32 v55, v217
    v_add_f32 v48, 1.0, v48
    v_add_f32 v49, 1.0, v49
    v_add_f32 v50, 1.0, v50
    v_mfma_f32_32x32x16_bf16 v[80:95], a[8:11], a[80:83], v[80:95]
    ds_read_b128 a[100:103], v2 offset:2640
    v_add_f32 v51, 1.0, v51
    v_add_f32 v52, 1.0, v52
    v_add_f32 v53, 1.0, v53
    v_add_f32 v54, 1.0, v54
    v_add_f32 v55, 1.0, v55
    v_mfma_f32_32x32x16_bf16 v[96:111], a[8:11], a[84:87], v[96:111]
    buffer_load_dwordx4 a[36:39], v3, s[36:39], s62 offen offset:1024 sc1
    v_rcp_f32 v48, v48
    v_rcp_f32 v49, v49
    v_mfma_f32_32x32x16_bf16 v[80:95], a[12:15], a[88:91], v[80:95]
    v_rcp_f32 v50, v50
    v_rcp_f32 v51, v51
    v_rcp_f32 v52, v52
    s_waitcnt lgkmcnt(1)
    v_mfma_f32_32x32x16_bf16 v[96:111], a[12:15], a[92:95], v[96:111]
    v_rcp_f32 v53, v53
    v_rcp_f32 v54, v54
    v_rcp_f32 v55, v55
    v_mfma_f32_32x32x16_bf16 v[112:127], a[12:15], a[96:99], v[112:127]
    ds_read_b128 a[104:107], v2 offset:688
    buffer_load_dwordx4 a[40:43], v3, s[36:39], s62 offen offset:2048 sc1
    v_mul_f32 v192, v192, v48
    v_mul_f32 v193, v193, v49
    v_mul_f32 v200, v200, v50
    v_mfma_f32_32x32x16_bf16 v[64:79], a[16:19], a[88:91], v[64:79]
    ds_read_b128 a[108:111], v2 offset:1344
    v_mul_f32 v201, v201, v51
    v_mul_f32 v208, v208, v52
    v_mul_f32 v209, v209, v53
    v_mul_f32 v216, v216, v54
    v_mul_f32 v217, v217, v55
    v_mfma_f32_32x32x16_bf16 v[80:95], a[16:19], a[92:95], v[80:95]
    ds_read_b128 a[112:115], v2 offset:2000
    v_cvt_pk_bf16_f32 v56, v192, v200
    v_cvt_pk_bf16_f32 v57, v208, v216
    v_cvt_pk_bf16_f32 v58, v193, v201
    v_mfma_f32_32x32x16_bf16 v[96:111], a[16:19], a[96:99], v[96:111]
    buffer_load_dwordx4 a[44:47], v3, s[36:39], s62 offen offset:3072 sc1
    v_cvt_pk_bf16_f32 v59, v209, v217
    s_waitcnt lgkmcnt(2)
    v_mfma_f32_32x32x16_bf16 v[112:127], a[16:19], a[100:103], v[112:127]
    ds_write_b64 v4, v[56:57] offset:0
    v_mfma_f32_32x32x16_bf16 v[64:79], a[20:23], a[92:95], v[64:79]
    ds_write_b64 v4, v[58:59] offset:16
    v_lshlrev_b32 v194, 16, v197
    v_and_b32 v195, s84, v197
    v_lshlrev_b32 v202, 16, v205
    v_and_b32 v203, s84, v205
    v_mfma_f32_32x32x16_bf16 v[80:95], a[20:23], a[96:99], v[80:95]
    ds_read_b128 a[116:119], v2 offset:2656
    buffer_load_dwordx4 a[48:51], v3, s[36:39], s63 offen offset:0 sc1
    v_lshlrev_b32 v210, 16, v213
    v_and_b32 v211, s84, v213
    v_lshlrev_b32 v218, 16, v221
    v_and_b32 v219, s84, v221
    v_mfma_f32_32x32x16_bf16 v[96:111], a[20:23], a[100:103], v[96:111]
    v_fma_f32 v194, v194, v250, v40
    v_fma_f32 v195, v195, v250, v40
    v_fma_f32 v202, v202, v251, v41
    v_fma_f32 v203, v203, v251, v41
    s_waitcnt vmcnt(6) lgkmcnt(3)
    v_mfma_f32_32x32x16_bf16 v[80:95], a[24:27], a[104:107], v[80:95]
    v_fma_f32 v210, v210, v252, v42
    v_fma_f32 v211, v211, v252, v42
    v_fma_f32 v218, v218, v253, v43
    v_fma_f32 v219, v219, v253, v43
    v_exp_f32 v48, v194
    v_mfma_f32_32x32x16_bf16 v[96:111], a[24:27], a[108:111], v[96:111]
    buffer_load_dwordx4 a[52:55], v3, s[36:39], s63 offen offset:1024 sc1
    v_exp_f32 v49, v195
    v_exp_f32 v50, v202
    v_exp_f32 v51, v203
    v_mfma_f32_32x32x16_bf16 v[112:127], a[24:27], a[112:115], v[112:127]
    ds_read_b128 a[72:75], v2 offset:32144
    v_exp_f32 v52, v210
    v_exp_f32 v53, v211
    s_waitcnt vmcnt(6) lgkmcnt(1)
    v_mfma_f32_32x32x16_bf16 v[64:79], a[28:31], a[104:107], v[64:79]
    ds_read_b128 a[76:79], v2 offset:32800
    v_exp_f32 v54, v218
    v_exp_f32 v55, v219
    v_add_f32 v48, 1.0, v48
    v_add_f32 v49, 1.0, v49
    v_mfma_f32_32x32x16_bf16 v[80:95], a[28:31], a[108:111], v[80:95]
    ds_read_b128 a[80:83], v2 offset:33456
    buffer_load_dwordx4 a[56:59], v3, s[36:39], s63 offen offset:2048 sc1
    v_add_f32 v50, 1.0, v50
    v_add_f32 v51, 1.0, v51
    v_add_f32 v52, 1.0, v52
    v_add_f32 v53, 1.0, v53
    v_add_f32 v54, 1.0, v54
    v_mfma_f32_32x32x16_bf16 v[96:111], a[28:31], a[112:115], v[96:111]
    v_add_f32 v55, 1.0, v55
    v_rcp_f32 v48, v48
    v_rcp_f32 v49, v49
    v_rcp_f32 v50, v50
    v_mfma_f32_32x32x16_bf16 v[112:127], a[28:31], a[116:119], v[112:127]
    v_rcp_f32 v51, v51
    v_rcp_f32 v52, v52
    v_rcp_f32 v53, v53
    s_waitcnt vmcnt(6) lgkmcnt(1)
    v_mfma_f32_32x32x16_bf16 v[64:79], a[32:35], a[108:111], v[64:79]
    buffer_load_dwordx4 a[60:63], v3, s[36:39], s63 offen offset:3072 sc1
    v_rcp_f32 v54, v54
    v_rcp_f32 v55, v55
    v_mfma_f32_32x32x16_bf16 v[80:95], a[32:35], a[112:115], v[80:95]
    ds_read_b128 a[84:87], v2 offset:34112
    v_mul_f32 v194, v194, v48
    v_mul_f32 v195, v195, v49
    v_mul_f32 v202, v202, v50
    v_mul_f32 v203, v203, v51
    v_mul_f32 v210, v210, v52
    v_mfma_f32_32x32x16_bf16 v[96:111], a[32:35], a[116:119], v[96:111]
    v_mul_f32 v211, v211, v53
    v_mul_f32 v218, v218, v54
    v_mul_f32 v219, v219, v55
    v_cvt_pk_bf16_f32 v56, v194, v202
    v_cvt_pk_bf16_f32 v57, v210, v218
    s_waitcnt vmcnt(6) lgkmcnt(1)
    v_mfma_f32_32x32x16_bf16 v[80:95], a[36:39], a[72:75], v[80:95]
    buffer_load_dwordx4 a[64:67], v3, s[36:39], s64 offen offset:0 sc1
    v_cvt_pk_bf16_f32 v58, v195, v203
    v_cvt_pk_bf16_f32 v59, v211, v219
    v_mfma_f32_32x32x16_bf16 v[96:111], a[36:39], a[76:79], v[96:111]
    ds_write_b64 v4, v[56:57] offset:32
    v_mfma_f32_32x32x16_bf16 v[112:127], a[36:39], a[80:83], v[112:127]
    ds_read_b128 a[88:91], v2 offset:32160
    ds_write_b64 v4, v[58:59] offset:48
    v_lshlrev_b32 v196, 16, v198
    v_and_b32 v197, s84, v198
    s_waitcnt vmcnt(6) lgkmcnt(3)
    v_mfma_f32_32x32x16_bf16 v[64:79], a[40:43], a[72:75], v[64:79]
    ds_read_b128 a[92:95], v2 offset:32816
    buffer_load_dwordx4 a[68:71], v3, s[36:39], s64 offen offset:1024 sc1
    v_lshlrev_b32 v204, 16, v206
    v_and_b32 v205, s84, v206
    v_lshlrev_b32 v212, 16, v214
    v_and_b32 v213, s84, v214
    v_lshlrev_b32 v220, 16, v222
    v_mfma_f32_32x32x16_bf16 v[80:95], a[40:43], a[76:79], v[80:95]
    ds_read_b128 a[96:99], v2 offset:33472
    v_and_b32 v221, s84, v222
    v_fma_f32 v196, v196, v250, v40
    v_fma_f32 v197, v197, v250, v40
    v_fma_f32 v204, v204, v251, v41
    v_mfma_f32_32x32x16_bf16 v[96:111], a[40:43], a[80:83], v[96:111]
    v_fma_f32 v205, v205, v251, v41
    v_fma_f32 v212, v212, v252, v42
    v_fma_f32 v213, v213, v252, v42
    v_fma_f32 v220, v220, v253, v43
    v_fma_f32 v221, v221, v253, v43
    v_mfma_f32_32x32x16_bf16 v[112:127], a[40:43], a[84:87], v[112:127]
    buffer_load_dwordx4 a[128:131], v150, s[36:39], 0 offen offset:0 sc1
    v_exp_f32 v48, v196
    v_exp_f32 v49, v197
    s_waitcnt vmcnt(7) lgkmcnt(1)
    v_mfma_f32_32x32x16_bf16 v[64:79], a[44:47], a[76:79], v[64:79]
    v_exp_f32 v50, v204
    v_exp_f32 v51, v205
    v_exp_f32 v52, v212
    v_mfma_f32_32x32x16_bf16 v[80:95], a[44:47], a[80:83], v[80:95]
    ds_read_b128 a[100:103], v2 offset:34128
    v_exp_f32 v53, v213
    v_exp_f32 v54, v220
    v_exp_f32 v55, v221
    v_mfma_f32_32x32x16_bf16 v[96:111], a[44:47], a[84:87], v[96:111]
    buffer_load_dwordx4 a[132:135], v150, s[36:39], 0 offen offset:1024 sc1
    v_add_f32 v48, 1.0, v48
    v_add_f32 v49, 1.0, v49
    v_add_f32 v50, 1.0, v50
    v_add_f32 v51, 1.0, v51
    v_add_f32 v52, 1.0, v52
    s_waitcnt vmcnt(7) lgkmcnt(1)
    v_mfma_f32_32x32x16_bf16 v[80:95], a[48:51], a[88:91], v[80:95]
    v_add_f32 v53, 1.0, v53
    v_add_f32 v54, 1.0, v54
    v_add_f32 v55, 1.0, v55
    v_rcp_f32 v48, v48
    v_rcp_f32 v49, v49
    v_mfma_f32_32x32x16_bf16 v[96:111], a[48:51], a[92:95], v[96:111]
    v_rcp_f32 v50, v50
    v_rcp_f32 v51, v51
    v_rcp_f32 v52, v52
    v_mfma_f32_32x32x16_bf16 v[112:127], a[48:51], a[96:99], v[112:127]
    ds_read_b128 a[104:107], v2 offset:32176
    buffer_load_dwordx4 a[136:139], v150, s[36:39], 0 offen offset:2048 sc1
    v_rcp_f32 v53, v53
    s_waitcnt vmcnt(7) lgkmcnt(1)
    v_mfma_f32_32x32x16_bf16 v[64:79], a[52:55], a[88:91], v[64:79]
    ds_read_b128 a[108:111], v2 offset:32832
    buffer_load_dwordx3 v[224:226], v254, s[40:43], 0 offen sc1
    v_rcp_f32 v54, v54
    v_rcp_f32 v55, v55
    v_mul_f32 v196, v196, v48
    v_mfma_f32_32x32x16_bf16 v[80:95], a[52:55], a[92:95], v[80:95]
    ds_read_b128 a[112:115], v2 offset:33488
    buffer_load_dwordx3 v[228:230], v254, s[40:43], 0 offen offset:128 sc1
    v_mul_f32 v197, v197, v49
    v_mul_f32 v204, v204, v50
    v_mul_f32 v205, v205, v51
    v_mfma_f32_32x32x16_bf16 v[96:111], a[52:55], a[96:99], v[96:111]
    buffer_load_dwordx4 a[140:143], v150, s[36:39], 0 offen offset:3072 sc1
    v_mul_f32 v212, v212, v52
    v_mul_f32 v213, v213, v53
    v_mul_f32 v220, v220, v54
    v_mul_f32 v221, v221, v55
    v_cvt_pk_bf16_f32 v56, v196, v204
    v_mfma_f32_32x32x16_bf16 v[112:127], a[52:55], a[100:103], v[112:127]
    v_cvt_pk_bf16_f32 v57, v212, v220
    v_cvt_pk_bf16_f32 v58, v197, v205
    v_cvt_pk_bf16_f32 v59, v213, v221
    s_waitcnt vmcnt(9) lgkmcnt(1)
    v_mfma_f32_32x32x16_bf16 v[64:79], a[56:59], a[92:95], v[64:79]
    ds_write_b64 v4, v[56:57] offset:64
    v_mfma_f32_32x32x16_bf16 v[80:95], a[56:59], a[96:99], v[80:95]
    ds_read_b128 a[116:119], v2 offset:34144
    buffer_load_dwordx4 a[144:147], v150, s[36:39], s61 offen offset:0 sc1
    ds_write_b64 v4, v[58:59] offset:80
    v_lshlrev_b32 v198, 16, v199
    v_and_b32 v199, s84, v199
    v_mfma_f32_32x32x16_bf16 v[96:111], a[56:59], a[100:103], v[96:111]
    v_lshlrev_b32 v206, 16, v207
    v_and_b32 v207, s84, v207
    v_lshlrev_b32 v214, 16, v215
    v_and_b32 v215, s84, v215
    v_lshlrev_b32 v222, 16, v223
    v_and_b32 v223, s84, v223
    s_waitcnt vmcnt(9) lgkmcnt(3)
    v_mfma_f32_32x32x16_bf16 v[80:95], a[60:63], a[104:107], v[80:95]
    v_fma_f32 v198, v198, v250, v40
    v_fma_f32 v199, v199, v250, v40
    v_fma_f32 v206, v206, v251, v41
    v_fma_f32 v207, v207, v251, v41
    v_fma_f32 v214, v214, v252, v42
    v_mfma_f32_32x32x16_bf16 v[96:111], a[60:63], a[108:111], v[96:111]
    buffer_load_dwordx4 a[148:151], v150, s[36:39], s61 offen offset:1024 sc1
    v_fma_f32 v215, v215, v252, v42
    v_fma_f32 v222, v222, v253, v43
    v_fma_f32 v223, v223, v253, v43
    v_exp_f32 v48, v198
    v_mfma_f32_32x32x16_bf16 v[112:127], a[60:63], a[112:115], v[112:127]
    ds_read_b128 a[72:75], v2 offset:4592
    v_exp_f32 v49, v199
    v_exp_f32 v50, v206
    s_waitcnt vmcnt(9) lgkmcnt(2)
    v_mfma_f32_32x32x16_bf16 v[64:79], a[64:67], a[104:107], v[64:79]
    ds_read_b128 a[76:79], v2 offset:5248
    v_exp_f32 v51, v207
    v_exp_f32 v52, v214
    v_exp_f32 v53, v215
    v_mfma_f32_32x32x16_bf16 v[80:95], a[64:67], a[108:111], v[80:95]
    ds_read_b128 a[80:83], v2 offset:5904
    buffer_load_dwordx4 a[152:155], v150, s[36:39], s61 offen offset:2048 sc1
    v_exp_f32 v54, v222
    v_exp_f32 v55, v223
    v_add_f32 v48, 1.0, v48
    v_mfma_f32_32x32x16_bf16 v[96:111], a[64:67], a[112:115], v[96:111]
    v_add_f32 v49, 1.0, v49
    v_add_f32 v50, 1.0, v50
    v_add_f32 v51, 1.0, v51
    v_add_f32 v52, 1.0, v52
    v_add_f32 v53, 1.0, v53
    v_add_f32 v54, 1.0, v54
    v_mfma_f32_32x32x16_bf16 v[112:127], a[64:67], a[116:119], v[112:127]
    v_add_f32 v55, 1.0, v55
    v_rcp_f32 v48, v48
    v_rcp_f32 v49, v49
    s_waitcnt vmcnt(9) lgkmcnt(1)
    v_mfma_f32_32x32x16_bf16 v[64:79], a[68:71], a[108:111], v[64:79]
    buffer_load_dwordx4 a[156:159], v150, s[36:39], s61 offen offset:3072 sc1
    v_rcp_f32 v50, v50
    v_rcp_f32 v51, v51
    v_mfma_f32_32x32x16_bf16 v[80:95], a[68:71], a[112:115], v[80:95]
    ds_read_b128 a[84:87], v2 offset:6560
    v_rcp_f32 v52, v52
    v_rcp_f32 v53, v53
    v_rcp_f32 v54, v54
    v_mfma_f32_32x32x16_bf16 v[96:111], a[68:71], a[116:119], v[96:111]
    v_rcp_f32 v55, v55
    v_mul_f32 v198, v198, v48
    v_mul_f32 v199, v199, v49
    s_waitcnt vmcnt(9) lgkmcnt(1)
    v_mfma_f32_32x32x16_bf16 v[80:95], a[128:131], a[72:75], v[80:95]
    buffer_load_dwordx4 a[160:163], v150, s[36:39], s62 offen offset:0 sc1
    v_mul_f32 v206, v206, v50
    v_mul_f32 v207, v207, v51
    v_mul_f32 v214, v214, v52
    v_mul_f32 v215, v215, v53
    v_mul_f32 v222, v222, v54
    v_mfma_f32_32x32x16_bf16 v[96:111], a[128:131], a[76:79], v[96:111]
    v_mul_f32 v223, v223, v55
    v_cvt_pk_bf16_f32 v56, v198, v206
    v_cvt_pk_bf16_f32 v57, v214, v222
    v_cvt_pk_bf16_f32 v58, v199, v207
    v_cvt_pk_bf16_f32 v59, v215, v223
    v_mfma_f32_32x32x16_bf16 v[112:127], a[128:131], a[80:83], v[112:127]
    ds_read_b128 a[88:91], v2 offset:4608
    ds_write_b64 v4, v[56:57] offset:96
    s_waitcnt vmcnt(9) lgkmcnt(2)
    v_mfma_f32_32x32x16_bf16 v[64:79], a[132:135], a[72:75], v[64:79]
    ds_read_b128 a[92:95], v2 offset:5264
    buffer_load_dwordx4 a[164:167], v150, s[36:39], s62 offen offset:1024 sc1
    ds_write_b64 v4, v[58:59] offset:112
    s_waitcnt vmcnt(7)
    v_xor_b32 v238, v8, v226
    v_mfma_f32_32x32x16_bf16 v[80:95], a[132:135], a[76:79], v[80:95]
    ds_read_b128 a[96:99], v2 offset:5920
    v_xor_b32 v239, v8, v230
    v_or_b32 v238, v238, v239
    v_cmp_ne_u32 vcc, 0, v238
    s_cbranch_vccz L_cn_ok
    s_mov_b32 s75, 0x4000
L_cn_re:
    buffer_load_dwordx3 v[224:226], v254, s[40:43], 0 offen sc1
    buffer_load_dwordx3 v[228:230], v254, s[40:43], 0 offen offset:128 sc1
    s_waitcnt vmcnt(0)
    v_xor_b32 v238, v8, v226
    v_xor_b32 v239, v8, v230
    v_or_b32 v238, v238, v239
    v_cmp_ne_u32 vcc, 0, v238
    s_nop 1
    s_cbranch_vccz L_cn_ok
    s_sub_u32 s75, s75, 1
    s_cbranch_scc0 L_cn_re
L_cn_ok:
    v_mfma_f32_32x32x16_bf16 v[96:111], a[132:135], a[80:83], v[96:111]
    v_perm_b32 v242, v225, v224, v255
    v_perm_b32 v243, v229, v228, v255
    v_fma_f32 v242, v242, v246, v247
    v_fma_f32 v243, v243, v248, v249
    v_exp_f32 v48, v242
    v_mfma_f32_32x32x16_bf16 v[112:127], a[132:135], a[84:87], v[112:127]
    buffer_load_dwordx4 a[168:171], v150, s[36:39], s62 offen offset:2048 sc1
    v_exp_f32 v49, v243
    v_add_f32 v48, 1.0, v48
    s_waitcnt lgkmcnt(2)
    v_mfma_f32_32x32x16_bf16 v[64:79], a[136:139], a[76:79], v[64:79]
    v_add_f32 v49, 1.0, v49
    v_rcp_f32 v48, v48
    v_rcp_f32 v49, v49
    v_mul_f32 v242, v242, v48
    v_mfma_f32_32x32x16_bf16 v[80:95], a[136:139], a[80:83], v[80:95]
    ds_read_b128 a[100:103], v2 offset:6576
    v_mul_f32 v243, v243, v49
    v_cvt_pk_bf16_f32 v56, v242, v243
    v_mfma_f32_32x32x16_bf16 v[96:111], a[136:139], a[84:87], v[96:111]
    buffer_load_dwordx4 a[172:175], v150, s[36:39], s62 offen offset:3072 sc1
    ds_write_b16 v233, v56
    s_waitcnt vmcnt(8) lgkmcnt(2)
    v_mfma_f32_32x32x16_bf16 v[80:95], a[140:143], a[88:91], v[80:95]
    ds_write_b16_d16_hi v233, v56 offset:3280
    v_mfma_f32_32x32x16_bf16 v[96:111], a[140:143], a[92:95], v[96:111]
    v_mfma_f32_32x32x16_bf16 v[112:127], a[140:143], a[96:99], v[112:127]
    ds_read_b128 a[104:107], v2 offset:4624
    buffer_load_dwordx4 a[176:179], v150, s[36:39], s63 offen offset:0 sc1
    v_fma_f32 v160, v160, v6, v36
    v_fma_f32 v161, v161, v6, v36
    s_waitcnt vmcnt(8) lgkmcnt(3)
    v_mfma_f32_32x32x16_bf16 v[64:79], a[144:147], a[88:91], v[64:79]
    ds_read_b128 a[108:111], v2 offset:5280
    v_fma_f32 v168, v168, v6, v37
    v_fma_f32 v169, v169, v6, v37
    v_fma_f32 v176, v176, v6, v38
    v_mfma_f32_32x32x16_bf16 v[80:95], a[144:147], a[92:95], v[80:95]
    ds_read_b128 a[112:115], v2 offset:5936
    v_fma_f32 v177, v177, v6, v38
    v_fma_f32 v184, v184, v6, v39
    s_waitcnt lgkmcnt(3)
    s_barrier
    v_mfma_f32_32x32x16_bf16 v[96:111], a[144:147], a[96:99], v[96:111]
    buffer_load_dwordx4 a[180:183], v150, s[36:39], s63 offen offset:1024 sc1
    v_fma_f32 v185, v185, v6, v39
    v_exp_f32 v48, v160
    v_exp_f32 v49, v161
    v_mfma_f32_32x32x16_bf16 v[112:127], a[144:147], a[100:103], v[112:127]
    v_exp_f32 v50, v168
    v_exp_f32 v51, v169
    v_exp_f32 v52, v176
    s_waitcnt vmcnt(8) lgkmcnt(1)
    v_mfma_f32_32x32x16_bf16 v[64:79], a[148:151], a[92:95], v[64:79]
    v_exp_f32 v53, v177
    v_exp_f32 v54, v184
    v_exp_f32 v55, v185
    v_add_f32 v48, 1.0, v48
    v_mfma_f32_32x32x16_bf16 v[80:95], a[148:151], a[96:99], v[80:95]
    ds_read_b128 a[116:119], v2 offset:6592
    buffer_load_dwordx4 a[184:187], v150, s[36:39], s63 offen offset:2048 sc1
    v_add_f32 v49, 1.0, v49
    v_add_f32 v50, 1.0, v50
    v_add_f32 v51, 1.0, v51
    v_add_f32 v52, 1.0, v52
    v_mfma_f32_32x32x16_bf16 v[96:111], a[148:151], a[100:103], v[96:111]
    v_add_f32 v53, 1.0, v53
    v_add_f32 v54, 1.0, v54
    v_add_f32 v55, 1.0, v55
    v_rcp_f32 v48, v48
    s_waitcnt vmcnt(8) lgkmcnt(1)
    v_mfma_f32_32x32x16_bf16 v[80:95], a[152:155], a[104:107], v[80:95]
    v_rcp_f32 v49, v49
    v_rcp_f32 v50, v50
    v_rcp_f32 v51, v51
    v_mfma_f32_32x32x16_bf16 v[96:111], a[152:155], a[108:111], v[96:111]
    buffer_load_dwordx4 a[188:191], v150, s[36:39], s63 offen offset:3072 sc1
    v_rcp_f32 v52, v52
    v_rcp_f32 v53, v53
    v_mfma_f32_32x32x16_bf16 v[112:127], a[152:155], a[112:115], v[112:127]
    ds_read_b128 a[72:75], v2 offset:36080
    v_rcp_f32 v54, v54
    v_rcp_f32 v55, v55
    v_mul_f32 v160, v160, v48
    s_waitcnt vmcnt(8) lgkmcnt(1)
    v_mfma_f32_32x32x16_bf16 v[64:79], a[156:159], a[104:107], v[64:79]
    ds_read_b128 a[76:79], v2 offset:36736
    v_mul_f32 v161, v161, v49
    v_mul_f32 v168, v168, v50
    v_mul_f32 v169, v169, v51
    v_mul_f32 v176, v176, v52
    v_mfma_f32_32x32x16_bf16 v[80:95], a[156:159], a[108:111], v[80:95]
    ds_read_b128 a[80:83], v2 offset:37392
    buffer_load_dwordx4 a[192:195], v150, s[36:39], s64 offen offset:0 sc1
    v_mul_f32 v177, v177, v53
    v_mul_f32 v184, v184, v54
    v_mul_f32 v185, v185, v55
    v_cvt_pk_bf16_f32 v56, v160, v168
    v_mfma_f32_32x32x16_bf16 v[96:111], a[156:159], a[112:115], v[96:111]
    v_cvt_pk_bf16_f32 v57, v176, v184
    v_cvt_pk_bf16_f32 v58, v161, v169
    v_cvt_pk_bf16_f32 v59, v177, v185
    v_mfma_f32_32x32x16_bf16 v[112:127], a[156:159], a[116:119], v[112:127]
    ds_write_b64 v7, v[56:57] offset:7872
    s_waitcnt vmcnt(8) lgkmcnt(2)
    v_mfma_f32_32x32x16_bf16 v[64:79], a[160:163], a[108:111], v[64:79]
    buffer_load_dwordx4 a[196:199], v150, s[36:39], s64 offen offset:1024 sc1
    ds_write_b64 v7, v[58:59] offset:7888
    v_fma_f32 v162, v162, v6, v36
    v_fma_f32 v163, v163, v6, v36
    v_mfma_f32_32x32x16_bf16 v[80:95], a[160:163], a[112:115], v[80:95]
    ds_read_b128 a[84:87], v2 offset:38048
    v_fma_f32 v170, v170, v6, v37
    v_fma_f32 v171, v171, v6, v37
    v_fma_f32 v178, v178, v6, v38
    v_mfma_f32_32x32x16_bf16 v[96:111], a[160:163], a[116:119], v[96:111]
    v_add_u32 v3, 36864, v3
    v_fma_f32 v179, v179, v6, v38
    v_fma_f32 v186, v186, v6, v39
    v_fma_f32 v187, v187, v6, v39
    v_exp_f32 v48, v162
    s_waitcnt vmcnt(8) lgkmcnt(3)
    v_mfma_f32_32x32x16_bf16 v[80:95], a[164:167], a[72:75], v[80:95]
    buffer_load_dwordx4 a[4:7], v3, s[36:39], 0 offen offset:1024 sc1
    v_exp_f32 v49, v163
    v_exp_f32 v50, v170
    v_exp_f32 v51, v171
    v_mfma_f32_32x32x16_bf16 v[96:111], a[164:167], a[76:79], v[96:111]
    v_exp_f32 v52, v178
    v_exp_f32 v53, v179
    v_exp_f32 v54, v186
    v_mfma_f32_32x32x16_bf16 v[112:127], a[164:167], a[80:83], v[112:127]
    ds_read_b128 a[88:91], v2 offset:36096
    v_exp_f32 v55, v187
    v_add_f32 v48, 1.0, v48
    v_add_f32 v49, 1.0, v49
    v_add_f32 v50, 1.0, v50
    s_waitcnt vmcnt(8) lgkmcnt(1)
    v_mfma_f32_32x32x16_bf16 v[64:79], a[168:171], a[72:75], v[64:79]
    ds_read_b128 a[92:95], v2 offset:36752
    buffer_load_dwordx4 a[16:19], v3, s[36:39], s61 offen offset:0 sc1
    v_add_f32 v51, 1.0, v51
    v_add_f32 v52, 1.0, v52
    v_add_f32 v53, 1.0, v53
    v_add_f32 v54, 1.0, v54
    v_add_f32 v55, 1.0, v55
    v_mfma_f32_32x32x16_bf16 v[80:95], a[168:171], a[76:79], v[80:95]
    ds_read_b128 a[96:99], v2 offset:37408
    v_rcp_f32 v48, v48
    v_rcp_f32 v49, v49
    v_rcp_f32 v50, v50
    v_mfma_f32_32x32x16_bf16 v[96:111], a[168:171], a[80:83], v[96:111]
    v_rcp_f32 v51, v51
    v_rcp_f32 v52, v52
    v_rcp_f32 v53, v53
    v_mfma_f32_32x32x16_bf16 v[112:127], a[168:171], a[84:87], v[112:127]
    buffer_load_dwordx4 a[28:31], v3, s[36:39], s61 offen offset:3072 sc1
    v_rcp_f32 v54, v54
    v_rcp_f32 v55, v55
    s_waitcnt vmcnt(9) lgkmcnt(1)
    v_mfma_f32_32x32x16_bf16 v[64:79], a[172:175], a[76:79], v[64:79]
    v_mul_f32 v162, v162, v48
    v_mul_f32 v163, v163, v49
    v_mul_f32 v170, v170, v50
    v_mul_f32 v171, v171, v51
    v_mul_f32 v178, v178, v52
    v_mfma_f32_32x32x16_bf16 v[80:95], a[172:175], a[80:83], v[80:95]
    ds_read_b128 a[100:103], v2 offset:38064
    v_mul_f32 v179, v179, v53
    v_mul_f32 v186, v186, v54
    v_mul_f32 v187, v187, v55
    v_cvt_pk_bf16_f32 v56, v162, v170
    v_cvt_pk_bf16_f32 v57, v178, v186
    v_mfma_f32_32x32x16_bf16 v[96:111], a[172:175], a[84:87], v[96:111]
    buffer_load_dwordx4 a[40:43], v3, s[36:39], s62 offen offset:2048 sc1
    v_cvt_pk_bf16_f32 v58, v163, v171
    v_cvt_pk_bf16_f32 v59, v179, v187
    s_waitcnt vmcnt(9) lgkmcnt(1)
    v_mfma_f32_32x32x16_bf16 v[80:95], a[176:179], a[88:91], v[80:95]
    ds_write_b64 v7, v[56:57] offset:7904
    v_mfma_f32_32x32x16_bf16 v[96:111], a[176:179], a[92:95], v[96:111]
    ds_write_b64 v7, v[58:59] offset:7920
    v_fma_f32 v164, v164, v6, v36
    v_fma_f32 v165, v165, v6, v36
    v_fma_f32 v172, v172, v6, v37
    v_fma_f32 v173, v173, v6, v37
    v_mfma_f32_32x32x16_bf16 v[112:127], a[176:179], a[96:99], v[112:127]
    ds_read_b128 a[104:107], v2 offset:36112
    buffer_load_dwordx4 a[52:55], v3, s[36:39], s63 offen offset:1024 sc1
    v_fma_f32 v180, v180, v6, v38
    v_fma_f32 v181, v181, v6, v38
    s_waitcnt vmcnt(9) lgkmcnt(3)
    v_mfma_f32_32x32x16_bf16 v[64:79], a[180:183], a[88:91], v[64:79]
    ds_read_b128 a[108:111], v2 offset:36768
    v_fma_f32 v188, v188, v6, v39
    v_fma_f32 v189, v189, v6, v39
    v_exp_f32 v48, v164
    v_exp_f32 v49, v165
    v_mfma_f32_32x32x16_bf16 v[80:95], a[180:183], a[92:95], v[80:95]
    ds_read_b128 a[112:115], v2 offset:37424
    v_exp_f32 v50, v172
    v_exp_f32 v51, v173
    v_exp_f32 v52, v180
    v_mfma_f32_32x32x16_bf16 v[96:111], a[180:183], a[96:99], v[96:111]
    buffer_load_dwordx4 a[64:67], v3, s[36:39], s64 offen offset:0 sc1
    v_exp_f32 v53, v181
    v_exp_f32 v54, v188
    v_exp_f32 v55, v189
    v_mfma_f32_32x32x16_bf16 v[112:127], a[180:183], a[100:103], v[112:127]
    v_add_f32 v48, 1.0, v48
    v_add_f32 v49, 1.0, v49
    v_add_f32 v50, 1.0, v50
    v_add_f32 v51, 1.0, v51
    v_add_f32 v52, 1.0, v52
    s_waitcnt vmcnt(9) lgkmcnt(1)
    v_mfma_f32_32x32x16_bf16 v[64:79], a[184:187], a[92:95], v[64:79]
    v_add_u32 v150, 36864, v150
    v_add_f32 v53, 1.0, v53
    v_add_f32 v54, 1.0, v54
    v_add_f32 v55, 1.0, v55
    v_rcp_f32 v48, v48
    v_mfma_f32_32x32x16_bf16 v[80:95], a[184:187], a[96:99], v[80:95]
    ds_read_b128 a[116:119], v2 offset:38080
    buffer_load_dwordx4 a[132:135], v150, s[36:39], 0 offen offset:1024 sc1
    v_rcp_f32 v49, v49
    v_rcp_f32 v50, v50
    v_mfma_f32_32x32x16_bf16 v[96:111], a[184:187], a[100:103], v[96:111]
    v_rcp_f32 v51, v51
    v_rcp_f32 v52, v52
    s_waitcnt vmcnt(9) lgkmcnt(1)
    v_mfma_f32_32x32x16_bf16 v[80:95], a[188:191], a[104:107], v[80:95]
    v_rcp_f32 v53, v53
    v_rcp_f32 v54, v54
    v_rcp_f32 v55, v55
    v_mul_f32 v164, v164, v48
    v_mfma_f32_32x32x16_bf16 v[96:111], a[188:191], a[108:111], v[96:111]
    buffer_load_dwordx4 a[144:147], v150, s[36:39], s61 offen offset:0 sc1
    v_mul_f32 v165, v165, v49
    v_mul_f32 v172, v172, v50
    v_mul_f32 v173, v173, v51
    v_mul_f32 v180, v180, v52
    v_mfma_f32_32x32x16_bf16 v[112:127], a[188:191], a[112:115], v[112:127]
    ds_read_b128 a[72:75], v2 offset:0
    v_mul_f32 v181, v181, v53
    v_mul_f32 v188, v188, v54
    v_mul_f32 v189, v189, v55
    v_cvt_pk_bf16_f32 v56, v164, v172
    s_waitcnt vmcnt(9) lgkmcnt(1)
    v_mfma_f32_32x32x16_bf16 v[64:79], a[192:195], a[104:107], v[64:79]
    ds_read_b128 a[76:79], v2 offset:3280
    v_cvt_pk_bf16_f32 v57, v180, v188
    v_cvt_pk_bf16_f32 v58, v165, v173
    v_cvt_pk_bf16_f32 v59, v181, v189
    v_mfma_f32_32x32x16_bf16 v[80:95], a[192:195], a[108:111], v[80:95]
    ds_read_b128 a[80:83], v2 offset:16
    buffer_load_dwordx4 a[156:159], v150, s[36:39], s61 offen offset:3072 sc1
    ds_write_b64 v7, v[56:57] offset:7936
    v_mfma_f32_32x32x16_bf16 v[96:111], a[192:195], a[112:115], v[96:111]
    ds_read_b128 a[84:87], v2 offset:3296
    ds_write_b64 v7, v[58:59] offset:7952
    v_fma_f32 v166, v166, v6, v36
    v_fma_f32 v167, v167, v6, v36
    v_mfma_f32_32x32x16_bf16 v[112:127], a[192:195], a[116:119], v[112:127]
    ds_read_b128 a[88:91], v2 offset:32
    v_fma_f32 v174, v174, v6, v37
    v_fma_f32 v175, v175, v6, v37
    v_fma_f32 v182, v182, v6, v38
    s_waitcnt vmcnt(9) lgkmcnt(5)
    v_mfma_f32_32x32x16_bf16 v[64:79], a[196:199], a[108:111], v[64:79]
    ds_read_b128 a[92:95], v2 offset:3312
    buffer_load_dwordx4 a[168:171], v150, s[36:39], s62 offen offset:2048 sc1
    v_fma_f32 v183, v183, v6, v38
    v_fma_f32 v190, v190, v6, v39
    v_mfma_f32_32x32x16_bf16 v[80:95], a[196:199], a[112:115], v[80:95]
    ds_read_b128 a[96:99], v2 offset:31488
    v_fma_f32 v191, v191, v6, v39
    v_exp_f32 v48, v166
    v_exp_f32 v49, v167
    v_mfma_f32_32x32x16_bf16 v[96:111], a[196:199], a[116:119], v[96:111]
    ds_read_b128 a[100:103], v2 offset:34768
    v_exp_f32 v50, v174
    v_exp_f32 v51, v175
    v_exp_f32 v52, v182
    v_mfma_f32_32x32x16_bf16 v[64:79], a[0:3], a[72:75], v[64:79]
    ds_read_b128 a[104:107], v2 offset:31504
    buffer_load_dwordx4 a[0:3], v3, s[36:39], 0 offen offset:0 sc1
    v_exp_f32 v53, v183
    v_exp_f32 v54, v190
    v_mfma_f32_32x32x16_bf16 v[112:127], a[8:11], a[76:79], v[112:127]
    ds_read_b128 a[108:111], v2 offset:34784
    v_exp_f32 v55, v191
    v_add_f32 v48, 1.0, v48
    v_add_f32 v49, 1.0, v49
    v_add_f32 v50, 1.0, v50
    s_waitcnt lgkmcnt(3)
    v_mfma_f32_32x32x16_bf16 v[64:79], a[12:15], a[80:83], v[64:79]
    ds_read_b128 a[112:115], v2 offset:31520
    v_add_f32 v51, 1.0, v51
    v_add_f32 v52, 1.0, v52
    v_add_f32 v53, 1.0, v53
    v_add_f32 v54, 1.0, v54
    v_add_f32 v55, 1.0, v55
    v_mfma_f32_32x32x16_bf16 v[112:127], a[20:23], a[84:87], v[112:127]
    ds_read_b128 a[116:119], v2 offset:34800
    buffer_load_dwordx4 a[8:11], v3, s[36:39], 0 offen offset:2048 sc1
    v_rcp_f32 v48, v48
    v_rcp_f32 v49, v49
    v_mfma_f32_32x32x16_bf16 v[64:79], a[24:27], a[88:91], v[64:79]
    ds_read_b128 a[72:75], v2 offset:3936
    v_rcp_f32 v50, v50
    v_rcp_f32 v51, v51
    v_rcp_f32 v52, v52
    v_mfma_f32_32x32x16_bf16 v[112:127], a[32:35], a[92:95], v[112:127]
    ds_read_b128 a[76:79], v2 offset:7216
    v_rcp_f32 v53, v53
    v_rcp_f32 v54, v54
    v_rcp_f32 v55, v55
    v_mfma_f32_32x32x16_bf16 v[64:79], a[36:39], a[96:99], v[64:79]
    ds_read_b128 a[80:83], v2 offset:3952
    buffer_load_dwordx4 a[12:15], v3, s[36:39], 0 offen offset:3072 sc1
    v_mul_f32 v166, v166, v48
    v_mul_f32 v167, v167, v49
    s_waitcnt lgkmcnt(3)
    v_mfma_f32_32x32x16_bf16 v[112:127], a[44:47], a[100:103], v[112:127]
    ds_read_b128 a[84:87], v2 offset:7232
    v_mul_f32 v174, v174, v50
    v_mul_f32 v175, v175, v51
    v_mul_f32 v182, v182, v52
    v_mul_f32 v183, v183, v53
    v_mul_f32 v190, v190, v54
    v_mfma_f32_32x32x16_bf16 v[64:79], a[48:51], a[104:107], v[64:79]
    ds_read_b128 a[88:91], v2 offset:3968
    v_mul_f32 v191, v191, v55
    v_cvt_pk_bf16_f32 v56, v166, v174
    v_cvt_pk_bf16_f32 v57, v182, v190
    v_cvt_pk_bf16_f32 v58, v167, v175
    v_mfma_f32_32x32x16_bf16 v[112:127], a[56:59], a[108:111], v[112:127]
    ds_read_b128 a[92:95], v2 offset:7248
    buffer_load_dwordx4 a[20:23], v3, s[36:39], s61 offen offset:1024 sc1
    v_cvt_pk_bf16_f32 v59, v183, v191
    v_mfma_f32_32x32x16_bf16 v[64:79], a[60:63], a[112:115], v[64:79]
    ds_read_b128 a[96:99], v2 offset:35424
    ds_write_b64 v7, v[56:57] offset:7968
    v_mfma_f32_32x32x16_bf16 v[112:127], a[68:71], a[116:119], v[112:127]
    ds_read_b128 a[100:103], v2 offset:38704
    ds_write_b64 v7, v[58:59] offset:7984
    s_waitcnt lgkmcnt(5)
    v_mfma_f32_32x32x16_bf16 v[64:79], a[128:131], a[72:75], v[64:79]
    ds_read_b128 a[104:107], v2 offset:35440
    buffer_load_dwordx4 a[24:27], v3, s[36:39], s61 offen offset:2048 sc1
    v_accvgpr_read_b32 v128, a120
    v_mfma_f32_32x32x16_bf16 v[112:127], a[136:139], a[76:79], v[112:127]
    ds_read_b128 a[108:111], v2 offset:38720
    v_accvgpr_read_b32 v129, a121
    v_accvgpr_read_b32 v130, a122
    v_mfma_f32_32x32x16_bf16 v[64:79], a[140:143], a[80:83], v[64:79]
    ds_read_b128 a[112:115], v2 offset:35456
    v_accvgpr_read_b32 v131, a123
    v_accvgpr_read_b32 v132, a124
    v_accvgpr_read_b32 v133, a125
    v_mfma_f32_32x32x16_bf16 v[112:127], a[148:151], a[84:87], v[112:127]
    ds_read_b128 a[116:119], v2 offset:38736
    buffer_load_dwordx4 a[32:35], v3, s[36:39], s62 offen offset:0 sc1
    v_lshlrev_b32 v128, 16, v128
    v_lshlrev_b32 v129, 16, v129
    s_waitcnt lgkmcnt(4)
    s_barrier
    v_mfma_f32_32x32x16_bf16 v[64:79], a[152:155], a[88:91], v[64:79]
    ds_read_b128 a[72:75], v2 offset:7872
    v_mul_f32 v138, s86, v128
    v_mul_f32 v139, s86, v129
    s_waitcnt vmcnt(15) lgkmcnt(3)
    v_mfma_f32_32x32x16_bf16 v[112:127], a[160:163], a[92:95], v[112:127]
    ds_read_b128 a[76:79], v2 offset:8528
    v_exp_f32 v138, v138
    v_exp_f32 v139, v139
    v_mfma_f32_32x32x16_bf16 v[64:79], a[164:167], a[96:99], v[64:79]
    ds_read_b128 a[80:83], v2 offset:9184
    buffer_load_dwordx4 a[36:39], v3, s[36:39], s62 offen offset:1024 sc1
    v_lshlrev_b32 v134, 16, v130
    v_and_b32 v135, s84, v130
    v_lshlrev_b32 v136, 16, v131
    v_mfma_f32_32x32x16_bf16 v[112:127], a[172:175], a[100:103], v[112:127]
    ds_read_b128 a[84:87], v2 offset:9840
    v_and_b32 v137, s84, v131
    v_add_f32 v138, 1.0, v138
    v_add_f32 v139, 1.0, v139
    v_lshlrev_b32 v140, 16, v132
    v_mfma_f32_32x32x16_bf16 v[64:79], a[176:179], a[104:107], v[64:79]
    v_and_b32 v141, s84, v132
    v_lshlrev_b32 v142, 16, v133
    v_and_b32 v143, s84, v133
    v_rcp_f32 v138, v138
    v_mfma_f32_32x32x16_bf16 v[112:127], a[184:187], a[108:111], v[112:127]
    buffer_load_dwordx4 a[44:47], v3, s[36:39], s62 offen offset:3072 sc1
    v_rcp_f32 v139, v139
    s_lshl_b32 s58, s70, 4
    s_waitcnt lgkmcnt(1)
    v_mfma_f32_32x32x16_bf16 v[64:79], a[188:191], a[112:115], v[64:79]
    s_add_u32 s58, s58, 125952
    v_mul_f32 v138, v138, v128
    v_mul_f32 v139, v139, v129
    v_mul_f32 v134, v134, v138
    v_mul_f32 v135, v135, v138
    v_mfma_f32_32x32x16_bf16 v[112:127], a[196:199], a[116:119], v[112:127]
    ds_read_b128 a[88:91], v2 offset:10496
    v_mul_f32 v136, v136, v138
    v_mul_f32 v137, v137, v138
    v_fmac_f32 v134, v140, v139
    s_waitcnt vmcnt(7) lgkmcnt(1)
    v_mfma_f32_32x32x16_bf16 v[64:79], a[0:3], a[72:75], v[64:79]
    buffer_load_dwordx4 a[48:51], v3, s[36:39], s63 offen offset:0 sc1
    v_fmac_f32 v135, v141, v139
    v_fmac_f32 v136, v142, v139
    v_fmac_f32 v137, v143, v139
    v_and_b32 v138, 3, v1
    v_mfma_f32_32x32x16_bf16 v[80:95], a[0:3], a[76:79], v[80:95]
    v_lshl_add_u32 v138, v138, 2, s58
    s_mov_b32 s90, 0xaaaaaaaa
    s_mov_b32 s91, 0xaaaaaaaa
    s_mov_b32 s96, 0xcccccccc
    s_mov_b32 s97, 0xcccccccc
    v_mfma_f32_32x32x16_bf16 v[96:111], a[0:3], a[80:83], v[96:111]
    v_add_f32_dpp v134, v134, v134 quad_perm:[1,0,3,2] row_mask:0xf bank_mask:0xf
    v_add_f32_dpp v135, v135, v135 quad_perm:[1,0,3,2] row_mask:0xf bank_mask:0xf
    v_add_f32_dpp v136, v136, v136 quad_perm:[1,0,3,2] row_mask:0xf bank_mask:0xf
    v_mfma_f32_32x32x16_bf16 v[112:127], a[0:3], a[84:87], v[112:127]
    ds_read_b128 a[92:95], v2 offset:11152
    buffer_load_dwordx4 a[56:59], v3, s[36:39], s63 offen offset:2048 sc1
    v_add_f32_dpp v137, v137, v137 quad_perm:[1,0,3,2] row_mask:0xf bank_mask:0xf
    v_cndmask_b32 v134, v134, v135, s[90:91]
    v_mfma_f32_32x32x16_bf16 v[64:79], a[4:7], a[76:79], v[64:79]
    ds_read_b128 a[96:99], v2 offset:7888
    v_cndmask_b32 v136, v136, v137, s[90:91]
    v_add_f32_dpp v134, v134, v134 quad_perm:[2,3,0,1] row_mask:0xf bank_mask:0xf
    s_nop 0
    v_add_f32_dpp v136, v136, v136 quad_perm:[2,3,0,1] row_mask:0xf bank_mask:0xf
    v_mfma_f32_32x32x16_bf16 v[80:95], a[4:7], a[80:83], v[80:95]
    ds_read_b128 a[100:103], v2 offset:8544
    v_cndmask_b32 v134, v134, v136, s[96:97]
    s_nop 1
    v_add_f32_dpp v134, v134, v134 row_ror:4 row_mask:0xf bank_mask:0xf
    s_nop 1
    v_add_f32_dpp v134, v134, v134 row_ror:8 row_mask:0xf bank_mask:0xf
    v_mov_b32 v128, v134
    v_mfma_f32_32x32x16_bf16 v[96:111], a[4:7], a[84:87], v[96:111]
    ds_read_b128 a[104:107], v2 offset:9200
    buffer_load_dwordx4 a[60:63], v3, s[36:39], s63 offen offset:3072 sc1
    v_permlane16_swap_b32 v134, v128
    v_add_f32 v134, v134, v128
    s_waitcnt vmcnt(9) lgkmcnt(3)
    v_mfma_f32_32x32x16_bf16 v[112:127], a[4:7], a[88:91], v[112:127]
    ds_read_b128 a[108:111], v2 offset:9856
    v_mov_b32 v128, v134
    s_nop 1
    v_permlane32_swap_b32 v134, v128
    v_add_f32 v134, v134, v128
    v_mfma_f32_32x32x16_bf16 v[64:79], a[8:11], a[80:83], v[64:79]
    s_mov_b64 exec, 15
    ds_write_b32 v138, v134
    s_mov_b64 exec, -1
    v_mfma_f32_32x32x16_bf16 v[80:95], a[8:11], a[84:87], v[80:95]
    buffer_load_dwordx4 a[68:71], v3, s[36:39], s64 offen offset:1024 sc1
    v_and_b32 v160, 31, v1
    v_lshrrev_b32 v161, 5, v1
    s_mul_i32 s56, s70, 15744
    v_mfma_f32_32x32x16_bf16 v[96:111], a[8:11], a[88:91], v[96:111]
    s_add_u32 s57, s56, 62976
    v_lshlrev_b32 v162, 3, v161
    v_lshl_add_u32 v16, v160, 4, v162
    s_add_u32 s58, s57, 688
    v_mfma_f32_32x32x16_bf16 v[112:127], a[8:11], a[92:95], v[112:127]
    ds_read_b128 a[112:115], v2 offset:10512
    v_add_u32 v16, s58, v16
    v_mov_b32 v164, 2147483632
    s_waitcnt vmcnt(9) lgkmcnt(2)
    v_mfma_f32_32x32x16_bf16 v[64:79], a[12:15], a[96:99], v[64:79]
    buffer_load_dwordx4 a[128:131], v150, s[36:39], 0 offen offset:0 sc1
    s_lshl_b32 s58, s71, 7
    s_waitcnt lgkmcnt(1)
    s_barrier
    v_mfma_f32_32x32x16_bf16 v[80:95], a[12:15], a[100:103], v[80:95]
    v_and_b32 v60, 1, v1
    v_lshlrev_b32 v60, 3, v60
    v_add_u32 v60, 125952, v60
    s_lshl_b32 s59, s70, 5
    v_mfma_f32_32x32x16_bf16 v[96:111], a[12:15], a[104:107], v[96:111]
    ds_read_b64 v[62:63], v60 offset:16
    s_add_u32 s58, s58, s59
    s_lshl_b32 s58, s58, 15
    s_lshl_b32 s59, s72, 8
    v_mfma_f32_32x32x16_bf16 v[112:127], a[12:15], a[108:111], v[112:127]
    ds_read_b128 a[116:119], v2 offset:11168
    buffer_load_dwordx4 a[136:139], v150, s[36:39], 0 offen offset:2048 sc1
    ds_read_b64 v[144:145], v60 offset:32
    s_add_u32 s58, s58, s59
    v_mfma_f32_32x32x16_bf16 v[64:79], a[16:19], a[100:103], v[64:79]
    ds_read_b128 a[72:75], v2 offset:7904
    ds_read_b64 v[146:147], v60 offset:48
    s_lshl_b32 s59, s73, 1
    s_add_u32 s58, s58, s59
    v_mfma_f32_32x32x16_bf16 v[80:95], a[16:19], a[104:107], v[80:95]
    ds_read_b128 a[76:79], v2 offset:8560
    ds_read_b64 v[60:61], v60
    v_and_b32 v163, 15, v160
    v_lshlrev_b32 v13, 15, v163
    v_mfma_f32_32x32x16_bf16 v[96:111], a[16:19], a[108:111], v[96:111]
    ds_read_b128 a[80:83], v2 offset:9216
    buffer_load_dwordx4 a[140:143], v150, s[36:39], 0 offen offset:3072 sc1
    v_lshl_add_u32 v13, v161, 4, v13
    s_waitcnt vmcnt(10) lgkmcnt(6)
    v_mfma_f32_32x32x16_bf16 v[112:127], a[16:19], a[112:115], v[112:127]
    ds_read_b128 a[84:87], v2 offset:9872
    v_lshrrev_b32 v163, 4, v160
    v_lshl_add_u32 v13, v163, 5, v13
    v_add_u32 v13, s58, v13
    v_mfma_f32_32x32x16_bf16 v[64:79], a[20:23], a[104:107], v[64:79]
    s_lshl_b32 s58, s71, 4
    s_lshl_b32 s59, s70, 2
    s_add_u32 s58, s58, s59
    s_lshl_b32 s58, s58, 18
    v_mfma_f32_32x32x16_bf16 v[80:95], a[20:23], a[108:111], v[80:95]
    buffer_load_dwordx4 a[148:151], v150, s[36:39], s61 offen offset:1024 sc1
    s_waitcnt lgkmcnt(6)
    v_add_f32 v62, v62, v144
    s_lshl_b32 s59, s72, 7
    v_mfma_f32_32x32x16_bf16 v[96:111], a[20:23], a[112:115], v[96:111]
    v_add_f32 v63, v63, v145
    s_waitcnt lgkmcnt(2)
    v_add_f32 v60, v60, v146
    s_add_u32 s59, s59, s73
    v_mfma_f32_32x32x16_bf16 v[112:127], a[20:23], a[116:119], v[112:127]
    ds_read_b128 a[88:91], v2 offset:10528
    v_add_f32 v61, v61, v147
    s_lshl_b32 s59, s59, 4
    s_waitcnt vmcnt(10) lgkmcnt(1)
    v_mfma_f32_32x32x16_bf16 v[64:79], a[24:27], a[72:75], v[64:79]
    buffer_load_dwordx4 a[152:155], v150, s[36:39], s61 offen offset:2048 sc1
    v_add_f32 v60, v60, v62
    v_add_f32 v61, v61, v63
    s_add_u32 s59, s58, s59
    v_mfma_f32_32x32x16_bf16 v[80:95], a[24:27], a[76:79], v[80:95]
    v_mul_f32 v60, s86, v60
    v_mul_f32 v62, s86, v61
    v_mov_b32 v61, v8
    v_lshlrev_b32 v14, 18, v161
    v_mfma_f32_32x32x16_bf16 v[96:111], a[24:27], a[80:83], v[96:111]
    v_mov_b32 v63, v8
    v_lshl_add_u32 v14, v160, 4, v14
    v_add_u32 v14, s59, v14
    v_add_u32 v163, 1, v160
    v_mfma_f32_32x32x16_bf16 v[112:127], a[24:27], a[84:87], v[112:127]
    ds_read_b128 a[92:95], v2 offset:11184
    buffer_load_dwordx4 a[160:163], v150, s[36:39], s62 offen offset:0 sc1
    buffer_store_dwordx4 v[60:63], v11, s[32:35], 0 offen sc1
    v_mfma_f32_32x32x16_bf16 v[64:79], a[28:31], a[76:79], v[64:79]
    ds_read_b128 a[96:99], v2 offset:39360
    v_and_b32 v163, 30, v163
    v_cmp_eq_u32 vcc, 0, v163
    v_and_b32 v165, 1, v160
    v_mfma_f32_32x32x16_bf16 v[80:95], a[28:31], a[80:83], v[80:95]
    ds_read_b128 a[100:103], v2 offset:40016
    v_lshlrev_b32 v165, 6, v165
    v_lshl_add_u32 v165, v161, 4, v165
    s_lshl_b32 s59, s74, 7
    v_mfma_f32_32x32x16_bf16 v[96:111], a[28:31], a[84:87], v[96:111]
    ds_read_b128 a[104:107], v2 offset:40672
    buffer_load_dwordx4 a[164:167], v150, s[36:39], s62 offen offset:1024 sc1
    s_add_u32 s59, s59, s58
    s_waitcnt vmcnt(13) lgkmcnt(3)
    v_mfma_f32_32x32x16_bf16 v[112:127], a[28:31], a[88:91], v[112:127]
    ds_read_b128 a[108:111], v2 offset:41328
    s_add_u32 s59, s59, 8388608
    v_add_u32 v165, s59, v165
    v_cndmask_b32 v15, v164, v165, vcc
    v_mfma_f32_32x32x16_bf16 v[64:79], a[32:35], a[80:83], v[64:79]
    v_mov_b32 v170, 0
    s_sub_u32 s59, s72, 1
    v_add_u32 v172, s59, v170
    s_sub_u32 s59, s73, 1
    v_mfma_f32_32x32x16_bf16 v[80:95], a[32:35], a[84:87], v[80:95]
    buffer_load_dwordx4 a[172:175], v150, s[36:39], s62 offen offset:3072 sc1
    v_add_u32 v173, s59, v160
    v_cmp_gt_u32 s[90:91], s81, v172
    v_cmp_gt_u32 vcc, s81, v173
    v_mfma_f32_32x32x16_bf16 v[96:111], a[32:35], a[88:91], v[96:111]
    s_nop 0
    s_and_b64 vcc, vcc, s[90:91]
    v_mov_b32 v166, 0
    v_cndmask_b32 v23, v166, -1, vcc
    v_mov_b32 v166, s72
    v_mfma_f32_32x32x16_bf16 v[112:127], a[32:35], a[92:95], v[112:127]
    ds_read_b128 a[112:115], v2 offset:41984
    v_cndmask_b32 v172, v166, v172, vcc
    v_mov_b32 v166, s73
    s_waitcnt vmcnt(13) lgkmcnt(1)
    v_mfma_f32_32x32x16_bf16 v[64:79], a[36:39], a[96:99], v[64:79]
    buffer_load_dwordx4 a[176:179], v150, s[36:39], s63 offen offset:0 sc1
    v_cndmask_b32 v173, v166, v173, vcc
    v_lshl_add_u32 v172, v172, 7, v173
    v_lshl_add_u32 v172, v172, 4, v162
    v_mfma_f32_32x32x16_bf16 v[80:95], a[36:39], a[100:103], v[80:95]
    v_add_u32 v17, s58, v172
    v_mul_u32_u24 v172, 656, v170
    v_lshl_add_u32 v172, v160, 4, v172
    v_add_u32 v172, v172, v162
    v_mfma_f32_32x32x16_bf16 v[96:111], a[36:39], a[104:107], v[96:111]
    s_add_u32 s59, s57, 16
    v_add_u32 v20, s59, v172
    v_mov_b32 v170, 5
    s_sub_u32 s59, s72, 1
    v_mfma_f32_32x32x16_bf16 v[112:127], a[36:39], a[108:111], v[112:127]
    ds_read_b128 a[116:119], v2 offset:42640
    buffer_load_dwordx4 a[180:183], v150, s[36:39], s63 offen offset:1024 sc1
    v_add_u32 v172, s59, v170
    s_sub_u32 s59, s73, 1
    v_mfma_f32_32x32x16_bf16 v[64:79], a[40:43], a[100:103], v[64:79]
    ds_read_b128 a[72:75], v2 offset:39376
    v_add_u32 v173, s59, v160
    v_cmp_gt_u32 s[90:91], s81, v172
    v_cmp_gt_u32 vcc, s81, v173
    s_nop 1
    s_and_b64 vcc, vcc, s[90:91]
    v_mfma_f32_32x32x16_bf16 v[80:95], a[40:43], a[104:107], v[80:95]
    ds_read_b128 a[76:79], v2 offset:40032
    v_mov_b32 v166, 0
    v_cndmask_b32 v24, v166, -1, vcc
    v_mov_b32 v166, s72
    v_mfma_f32_32x32x16_bf16 v[96:111], a[40:43], a[108:111], v[96:111]
    ds_read_b128 a[80:83], v2 offset:40688
    buffer_load_dwordx4 a[184:187], v150, s[36:39], s63 offen offset:2048 sc1
    v_cndmask_b32 v172, v166, v172, vcc
    s_waitcnt vmcnt(15) lgkmcnt(3)
    v_mfma_f32_32x32x16_bf16 v[112:127], a[40:43], a[112:115], v[112:127]
    ds_read_b128 a[84:87], v2 offset:41344
    v_mov_b32 v166, s73
    v_cndmask_b32 v173, v166, v173, vcc
    v_lshl_add_u32 v172, v172, 7, v173
    v_mfma_f32_32x32x16_bf16 v[64:79], a[44:47], a[104:107], v[64:79]
    v_lshl_add_u32 v172, v172, 4, v162
    v_add_u32 v18, s58, v172
    v_mul_u32_u24 v172, 656, v170
    v_lshl_add_u32 v172, v160, 4, v172
    v_mfma_f32_32x32x16_bf16 v[80:95], a[44:47], a[108:111], v[80:95]
    buffer_load_dwordx4 a[188:191], v150, s[36:39], s63 offen offset:3072 sc1
    v_add_u32 v172, v172, v162
    s_add_u32 s59, s57, 16
    v_add_u32 v21, s59, v172
    v_mfma_f32_32x32x16_bf16 v[96:111], a[44:47], a[112:115], v[96:111]
    v_add_u32 v170, -7, v160
    v_add_u32 v171, -3, v160
    v_cmp_gt_u32 vcc, 8, v160
    s_nop 1
    v_cndmask_b32 v170, v170, v171, vcc
    v_mfma_f32_32x32x16_bf16 v[112:127], a[44:47], a[116:119], v[112:127]
    ds_read_b128 a[88:91], v2 offset:42000
    v_mov_b32 v171, 33
    v_cndmask_b32 v171, v171, 0, vcc
    s_waitcnt vmcnt(15) lgkmcnt(1)
    v_mfma_f32_32x32x16_bf16 v[64:79], a[48:51], a[72:75], v[64:79]
    buffer_load_dwordx4 a[192:195], v150, s[36:39], s64 offen offset:0 sc1
    v_add_u32 v174, 30, v160
    v_cmp_gt_u32 vcc, 4, v160
    s_nop 1
    v_cndmask_b32 v170, v170, 5, vcc
    v_mfma_f32_32x32x16_bf16 v[80:95], a[48:51], a[76:79], v[80:95]
    v_cndmask_b32 v171, v171, v174, vcc
    v_add_u32 v174, 32, v160
    v_cmp_gt_u32 vcc, 2, v160
    s_nop 1
    v_cndmask_b32 v170, v170, 0, vcc
    v_mfma_f32_32x32x16_bf16 v[96:111], a[48:51], a[80:83], v[96:111]
    v_cndmask_b32 v171, v171, v174, vcc
    v_cmp_gt_u32 s[96:97], 12, v160
    s_nop 1
    v_cndmask_b32 v170, 0, v170, s[96:97]
    v_mov_b32 v174, 36
    v_mfma_f32_32x32x16_bf16 v[112:127], a[48:51], a[84:87], v[112:127]
    ds_read_b128 a[92:95], v2 offset:42656
    buffer_load_dwordx4 a[196:199], v150, s[36:39], s64 offen offset:1024 sc1
    v_cndmask_b32 v171, v174, v171, s[96:97]
    s_sub_u32 s59, s72, 1
    v_mfma_f32_32x32x16_bf16 v[64:79], a[52:55], a[76:79], v[64:79]
    ds_read_b128 a[96:99], v2 offset:39392
    v_add_u32 v172, s59, v170
    s_sub_u32 s59, s73, 1
    v_add_u32 v173, s59, v171
    v_mfma_f32_32x32x16_bf16 v[80:95], a[52:55], a[80:83], v[80:95]
    ds_read_b128 a[100:103], v2 offset:40048
    v_add_u32 v3, 36864, v3
    v_cmp_gt_u32 s[90:91], s81, v172
    v_cmp_gt_u32 vcc, s81, v173
    v_mfma_f32_32x32x16_bf16 v[96:111], a[52:55], a[84:87], v[96:111]
    ds_read_b128 a[104:107], v2 offset:40704
    buffer_load_dwordx4 a[0:3], v3, s[36:39], 0 offen offset:0 sc1
    s_and_b64 vcc, vcc, s[90:91]
    s_waitcnt vmcnt(17) lgkmcnt(3)
    v_mfma_f32_32x32x16_bf16 v[112:127], a[52:55], a[88:91], v[112:127]
    ds_read_b128 a[108:111], v2 offset:41360
    s_and_b64 vcc, vcc, s[96:97]
    v_mov_b32 v166, 0
    v_cndmask_b32 v25, v166, -1, vcc
    v_mfma_f32_32x32x16_bf16 v[64:79], a[56:59], a[80:83], v[64:79]
    buffer_load_dwordx4 v[144:147], v12, s[32:35], 0 offen sc1
    v_mov_b32 v166, s72
    v_cndmask_b32 v172, v166, v172, vcc
    v_mov_b32 v166, s73
    v_mfma_f32_32x32x16_bf16 v[80:95], a[56:59], a[84:87], v[80:95]
    buffer_load_dwordx4 a[4:7], v3, s[36:39], 0 offen offset:1024 sc1
    v_cndmask_b32 v173, v166, v173, vcc
    v_lshl_add_u32 v172, v172, 7, v173
    v_lshl_add_u32 v172, v172, 4, v162
    v_mfma_f32_32x32x16_bf16 v[96:111], a[56:59], a[88:91], v[96:111]
    v_add_u32 v19, s58, v172
    v_mul_u32_u24 v172, 656, v170
    v_lshl_add_u32 v172, v171, 4, v172
    v_add_u32 v172, v172, v162
    v_mfma_f32_32x32x16_bf16 v[112:127], a[56:59], a[92:95], v[112:127]
    ds_read_b128 a[112:115], v2 offset:42016
    s_add_u32 s59, s57, 16
    v_add_u32 v22, s59, v172
    s_waitcnt vmcnt(18) lgkmcnt(1)
    v_mfma_f32_32x32x16_bf16 v[64:79], a[60:63], a[96:99], v[64:79]
    buffer_load_dwordx4 a[8:11], v3, s[36:39], 0 offen offset:2048 sc1
    v_and_b32 v172, 3, v160
    v_add_u32 v172, -1, v172
    v_cmp_gt_u32 vcc, 2, v172
    v_mfma_f32_32x32x16_bf16 v[80:95], a[60:63], a[100:103], v[80:95]
    v_add_u32 v173, -4, v160
    v_cmp_gt_u32 s[90:91], 8, v173
    s_nop 1
    s_and_b64 vcc, vcc, s[90:91]
    v_cmp_ne_u32 s[90:91], 0, v25
    v_mfma_f32_32x32x16_bf16 v[96:111], a[60:63], a[104:107], v[96:111]
    s_nop 0
    s_and_b64 s[96:97], vcc, s[90:91]
    v_lshrrev_b32 v173, 3, v160
    v_lshlrev_b32 v173, 1, v173
    v_add_u32 v173, -1, v173
    v_mfma_f32_32x32x16_bf16 v[112:127], a[60:63], a[108:111], v[112:127]
    ds_read_b128 a[116:119], v2 offset:42672
    buffer_load_dwordx4 a[12:15], v3, s[36:39], 0 offen offset:3072 sc1
    v_add_u32 v173, s74, v173
    v_lshlrev_b32 v173, 7, v173
    v_mfma_f32_32x32x16_bf16 v[64:79], a[64:67], a[100:103], v[64:79]
    ds_read_b128 a[72:75], v2 offset:11808
    v_lshl_add_u32 v173, v172, 5, v173
    v_lshl_add_u32 v173, v161, 4, v173
    v_lshrrev_b32 v172, 3, v160
    v_mfma_f32_32x32x16_bf16 v[80:95], a[64:67], a[104:107], v[80:95]
    ds_read_b128 a[76:79], v2 offset:12464
    v_xor_b32 v172, 1, v172
    v_lshl_add_u32 v173, v172, 6, v173
    s_add_u32 s59, s58, 8388608
    v_mfma_f32_32x32x16_bf16 v[96:111], a[64:67], a[108:111], v[96:111]
    ds_read_b128 a[80:83], v2 offset:13120
    buffer_load_dwordx4 a[16:19], v3, s[36:39], s61 offen offset:0 sc1
    v_add_u32 v173, s59, v173
    s_waitcnt vmcnt(16) lgkmcnt(3)
    v_mfma_f32_32x32x16_bf16 v[112:127], a[64:67], a[112:115], v[112:127]
    ds_read_b128 a[84:87], v2 offset:11824
    v_cndmask_b32 v19, v19, v173, s[96:97]
    v_mov_b32 v40, 0
    v_mov_b32 v41, 0
    v_mfma_f32_32x32x16_bf16 v[64:79], a[68:71], a[104:107], v[64:79]
    ds_read_b128 a[88:91], v2 offset:12480
    v_mov_b32 v42, 0
    v_mov_b32 v43, 0
    v_mov_b32 v226, v8
    v_mfma_f32_32x32x16_bf16 v[80:95], a[68:71], a[108:111], v[80:95]
    ds_read_b128 a[92:95], v2 offset:13136
    buffer_load_dwordx4 a[20:23], v3, s[36:39], s61 offen offset:1024 sc1
    v_mov_b32 v230, v8
    v_mov_b32 v234, v8
    v_mfma_f32_32x32x16_bf16 v[96:111], a[68:71], a[112:115], v[96:111]
    ds_read_b128 a[96:99], v2 offset:11840
    v_mov_b32 v238, v8
    v_mov_b32 v210, v8
    v_mov_b32 v214, v8
    v_mfma_f32_32x32x16_bf16 v[112:127], a[68:71], a[116:119], v[112:127]
    ds_read_b128 a[100:103], v2 offset:12496
    v_mov_b32 v218, v8
    v_mov_b32 v222, v8
    s_waitcnt vmcnt(13) lgkmcnt(3)
    v_mfma_f32_32x32x16_bf16 v[64:79], a[128:131], a[72:75], v[64:79]
    ds_read_b128 a[104:107], v2 offset:13152
    buffer_load_dwordx4 a[24:27], v3, s[36:39], s61 offen offset:2048 sc1
    v_mfma_f32_32x32x16_bf16 v[64:79], a[132:135], a[76:79], v[64:79]
    ds_read_b128 a[108:111], v2 offset:43296
    v_mfma_f32_32x32x16_bf16 v[64:79], a[136:139], a[80:83], v[64:79]
    ds_read_b128 a[112:115], v2 offset:43952
    v_mfma_f32_32x32x16_bf16 v[64:79], a[140:143], a[84:87], v[64:79]
    ds_read_b128 a[116:119], v2 offset:44608
    buffer_load_dwordx4 a[28:31], v3, s[36:39], s61 offen offset:3072 sc1
    v_mfma_f32_32x32x16_bf16 v[64:79], a[144:147], a[88:91], v[64:79]
    ds_read_b128 a[72:75], v2 offset:43312
    s_waitcnt vmcnt(10) lgkmcnt(3)
    v_mfma_f32_32x32x16_bf16 v[64:79], a[148:151], a[92:95], v[64:79]
    ds_read_b128 a[76:79], v2 offset:43968
    v_mfma_f32_32x32x16_bf16 v[64:79], a[152:155], a[96:99], v[64:79]
    ds_read_b128 a[80:83], v2 offset:44624
    buffer_load_dwordx4 a[32:35], v3, s[36:39], s62 offen offset:0 sc1
    v_mfma_f32_32x32x16_bf16 v[64:79], a[156:159], a[100:103], v[64:79]
    ds_read_b128 a[84:87], v2 offset:43328
    s_waitcnt vmcnt(8)
    v_xor_b32 v60, v8, v145
    v_xor_b32 v61, v8, v147
    v_mfma_f32_32x32x16_bf16 v[64:79], a[160:163], a[104:107], v[64:79]
    ds_read_b128 a[88:91], v2 offset:43984
    v_or_b32 v60, v60, v61
    v_cmp_ne_u32 vcc, 0, v60
    s_cbranch_vccz L_e_ok
    s_mov_b32 s75, 0x4000
L_e_re:
    buffer_load_dwordx4 v[144:147], v12, s[32:35], 0 offen sc1
    s_waitcnt vmcnt(0)
    v_xor_b32 v60, v8, v145
    v_xor_b32 v61, v8, v147
    v_or_b32 v60, v60, v61
    v_cmp_ne_u32 vcc, 0, v60
    s_nop 1
    s_cbranch_vccz L_e_ok
    s_sub_u32 s75, s75, 1
    s_cbranch_scc0 L_e_re
L_e_ok:
    v_mfma_f32_32x32x16_bf16 v[64:79], a[164:167], a[108:111], v[64:79]
    ds_read_b128 a[92:95], v2 offset:44640
    buffer_load_dwordx4 a[36:39], v3, s[36:39], s62 offen offset:1024 sc1
    s_waitcnt lgkmcnt(3)
    v_mfma_f32_32x32x16_bf16 v[64:79], a[168:171], a[112:115], v[64:79]
    ds_read_b128 a[96:99], v2 offset:13776
    v_add_f32_dpp v144, v144, v144 row_ror:8 row_mask:0xf bank_mask:0xf
    v_add_f32_dpp v146, v146, v146 row_ror:8 row_mask:0xf bank_mask:0xf
    v_lshrrev_b32 v60, 4, v1
    v_mfma_f32_32x32x16_bf16 v[64:79], a[172:175], a[116:119], v[64:79]
    ds_read_b128 a[100:103], v2 offset:14432
    v_and_b32 v61, 3, v1
    v_add_f32_dpp v144, v144, v144 row_ror:4 row_mask:0xf bank_mask:0xf
    v_add_f32_dpp v145, v146, v146 row_ror:4 row_mask:0xf bank_mask:0xf
    v_mfma_f32_32x32x16_bf16 v[64:79], a[176:179], a[72:75], v[64:79]
    ds_read_b128 a[104:107], v2 offset:15088
    buffer_load_dwordx4 a[40:43], v3, s[36:39], s62 offen offset:2048 sc1
    v_lshlrev_b32 v60, 5, v60
    v_lshl_add_u32 v60, v61, 3, v60
    v_mfma_f32_32x32x16_bf16 v[64:79], a[180:183], a[76:79], v[64:79]
    ds_read_b128 a[108:111], v2 offset:13792
    s_lshl_b32 s56, s70, 7
    s_add_u32 s56, s56, 126016
    v_add_u32 v60, s56, v60
    v_mfma_f32_32x32x16_bf16 v[64:79], a[184:187], a[80:83], v[64:79]
    ds_read_b128 a[112:115], v2 offset:14448
    v_lshrrev_b32 v61, 5, v1
    v_lshl_add_u32 v61, v61, 4, s56
    s_waitcnt lgkmcnt(3)
    v_mfma_f32_32x32x16_bf16 v[64:79], a[188:191], a[84:87], v[64:79]
    ds_read_b128 a[116:119], v2 offset:15104
    buffer_load_dwordx4 a[44:47], v3, s[36:39], s62 offen offset:3072 sc1
    v_mfma_f32_32x32x16_bf16 v[64:79], a[192:195], a[88:91], v[64:79]
    ds_read_b128 a[72:75], v2 offset:13808
    s_mov_b32 exec_lo, 0x000f000f
    s_mov_b32 exec_hi, 0x000f000f
    ds_write_b64 v60, v[144:145]
    s_mov_b64 exec, -1
    v_mfma_f32_32x32x16_bf16 v[64:79], a[196:199], a[92:95], v[64:79]
    ds_read_b128 a[76:79], v2 offset:14464
    ds_read_b128 v[128:131], v61 offset:0
    v_mfma_f32_32x32x16_bf16 v[112:127], a[128:131], a[96:99], v[112:127]
    ds_read_b128 a[80:83], v2 offset:15120
    buffer_load_dwordx4 a[48:51], v3, s[36:39], s63 offen offset:0 sc1
    ds_read_b128 v[132:135], v61 offset:32
    v_mfma_f32_32x32x16_bf16 v[112:127], a[132:135], a[100:103], v[112:127]
    ds_read_b128 a[84:87], v2 offset:45264
    ds_read_b128 v[136:139], v61 offset:64
    s_waitcnt lgkmcnt(7)
    v_mfma_f32_32x32x16_bf16 v[112:127], a[136:139], a[104:107], v[112:127]
    ds_read_b128 a[88:91], v2 offset:45920
    ds_read_b128 v[140:143], v61 offset:96
    v_mfma_f32_32x32x16_bf16 v[112:127], a[140:143], a[108:111], v[112:127]
    ds_read_b128 a[92:95], v2 offset:46576
    buffer_load_dwordx4 a[52:55], v3, s[36:39], s63 offen offset:1024 sc1
    s_waitcnt lgkmcnt(7)
    v_add_f32 v64, v64, v128
    v_add_f32 v65, v65, v129
    v_add_f32 v66, v66, v130
    v_mfma_f32_32x32x16_bf16 v[112:127], a[144:147], a[112:115], v[112:127]
    ds_read_b128 a[96:99], v2 offset:45280
    v_add_f32 v67, v67, v131
    s_waitcnt lgkmcnt(6)
    v_add_f32 v68, v68, v132
    v_add_f32 v69, v69, v133
    v_add_f32 v70, v70, v134
    v_mfma_f32_32x32x16_bf16 v[112:127], a[148:151], a[116:119], v[112:127]
    ds_read_b128 a[100:103], v2 offset:45936
    v_add_f32 v71, v71, v135
    s_waitcnt lgkmcnt(5)
    v_add_f32 v72, v72, v136
    v_add_f32 v73, v73, v137
    v_mfma_f32_32x32x16_bf16 v[112:127], a[152:155], a[72:75], v[112:127]
    ds_read_b128 a[104:107], v2 offset:46592
    buffer_load_dwordx4 a[56:59], v3, s[36:39], s63 offen offset:2048 sc1
    v_add_f32 v74, v74, v138
    v_add_f32 v75, v75, v139
    s_waitcnt lgkmcnt(3)
    v_mfma_f32_32x32x16_bf16 v[112:127], a[156:159], a[76:79], v[112:127]
    ds_read_b128 a[108:111], v2 offset:45296
    v_add_f32 v76, v76, v140
    v_add_f32 v77, v77, v141
    v_add_f32 v78, v78, v142
    v_add_f32 v79, v79, v143
    v_mfma_f32_32x32x16_bf16 v[112:127], a[160:163], a[80:83], v[112:127]
    ds_read_b128 a[112:115], v2 offset:45952
    v_cvt_pk_bf16_f32 v32, v64, v65
    v_cvt_pk_bf16_f32 v33, v66, v67
    v_cvt_pk_bf16_f32 v34, v68, v69
    v_mfma_f32_32x32x16_bf16 v[112:127], a[164:167], a[84:87], v[112:127]
    ds_read_b128 a[116:119], v2 offset:46608
    buffer_load_dwordx4 a[60:63], v3, s[36:39], s63 offen offset:3072 sc1
    v_cvt_pk_bf16_f32 v35, v70, v71
    v_cvt_pk_bf16_f32 v36, v72, v73
    v_mfma_f32_32x32x16_bf16 v[112:127], a[168:171], a[88:91], v[112:127]
    ds_read_b128 a[72:75], v2 offset:12464
    v_cvt_pk_bf16_f32 v37, v74, v75
    v_cvt_pk_bf16_f32 v38, v76, v77
    v_cvt_pk_bf16_f32 v39, v78, v79
    v_permlane32_swap_b32 v32, v34
    v_mfma_f32_32x32x16_bf16 v[112:127], a[172:175], a[92:95], v[112:127]
    ds_read_b128 a[76:79], v2 offset:13120
    v_permlane32_swap_b32 v33, v35
    v_permlane32_swap_b32 v36, v38
    s_waitcnt lgkmcnt(3)
    v_mfma_f32_32x32x16_bf16 v[112:127], a[176:179], a[96:99], v[112:127]
    ds_read_b128 a[80:83], v2 offset:13776
    buffer_load_dwordx4 a[64:67], v3, s[36:39], s64 offen offset:0 sc1
    v_permlane32_swap_b32 v37, v39
    v_mfma_f32_32x32x16_bf16 v[112:127], a[180:183], a[100:103], v[112:127]
    ds_read_b128 a[84:87], v2 offset:12480
    buffer_store_dwordx4 v[32:35], v14, s[40:43], 0 offen offset:0 sc1
    v_add_f32 v40, v40, v64
    v_fmac_f32 v42, v64, v64
    v_mfma_f32_32x32x16_bf16 v[112:127], a[184:187], a[104:107], v[112:127]
    ds_read_b128 a[88:91], v2 offset:13136
    v_add_f32 v41, v41, v65
    v_fmac_f32 v43, v65, v65
    v_add_f32 v40, v40, v66
    v_fmac_f32 v42, v66, v66
    v_add_f32 v41, v41, v67
    v_mfma_f32_32x32x16_bf16 v[112:127], a[188:191], a[108:111], v[112:127]
    ds_read_b128 a[92:95], v2 offset:13792
    buffer_load_dwordx4 a[68:71], v3, s[36:39], s64 offen offset:1024 sc1
    v_fmac_f32 v43, v67, v67
    v_add_f32 v40, v40, v68
    v_fmac_f32 v42, v68, v68
    v_add_f32 v41, v41, v69
    v_mfma_f32_32x32x16_bf16 v[112:127], a[192:195], a[112:115], v[112:127]
    ds_read_b128 a[96:99], v2 offset:12496
    v_fmac_f32 v43, v69, v69
    v_add_f32 v40, v40, v70
    v_fmac_f32 v42, v70, v70
    v_add_f32 v41, v41, v71
    s_waitcnt lgkmcnt(3)
    v_mfma_f32_32x32x16_bf16 v[112:127], a[196:199], a[116:119], v[112:127]
    ds_read_b128 a[100:103], v2 offset:13152
    v_fmac_f32 v43, v71, v71
    v_add_f32 v40, v40, v72
    v_fmac_f32 v42, v72, v72
    v_add_f32 v41, v41, v73
    v_fmac_f32 v43, v73, v73
    v_mfma_f32_32x32x16_bf16 v[80:95], a[128:131], a[72:75], v[80:95]
    ds_read_b128 a[104:107], v2 offset:13808
    buffer_store_dwordx4 v[36:39], v14, s[40:43], s77 offen offset:0 sc1
    v_mfma_f32_32x32x16_bf16 v[80:95], a[132:135], a[76:79], v[80:95]
    ds_read_b128 a[108:111], v2 offset:43952
    v_mfma_f32_32x32x16_bf16 v[80:95], a[136:139], a[80:83], v[80:95]
    ds_read_b128 a[112:115], v2 offset:44608
    v_mfma_f32_32x32x16_bf16 v[80:95], a[140:143], a[84:87], v[80:95]
    ds_read_b128 a[116:119], v2 offset:45264
    v_add_f32 v112, v112, v128
    v_add_f32 v113, v113, v129
    v_add_f32 v114, v114, v130
    s_waitcnt lgkmcnt(3)
    v_mfma_f32_32x32x16_bf16 v[80:95], a[144:147], a[88:91], v[80:95]
    ds_read_b128 a[72:75], v2 offset:43968
    v_add_f32 v115, v115, v131
    v_add_f32 v116, v116, v132
    v_add_f32 v117, v117, v133
    v_add_f32 v118, v118, v134
    v_add_f32 v119, v119, v135
    v_mfma_f32_32x32x16_bf16 v[80:95], a[148:151], a[92:95], v[80:95]
    ds_read_b128 a[76:79], v2 offset:44624
    v_add_f32 v120, v120, v136
    v_add_f32 v121, v121, v137
    v_add_f32 v122, v122, v138
    v_add_f32 v123, v123, v139
    v_mfma_f32_32x32x16_bf16 v[80:95], a[152:155], a[96:99], v[80:95]
    ds_read_b128 a[80:83], v2 offset:45280
    v_add_f32 v124, v124, v140
    v_add_f32 v125, v125, v141
    v_add_f32 v126, v126, v142
    v_add_f32 v127, v127, v143
    v_mfma_f32_32x32x16_bf16 v[80:95], a[156:159], a[100:103], v[80:95]
    ds_read_b128 a[84:87], v2 offset:43984
    v_cvt_pk_bf16_f32 v32, v112, v113
    v_cvt_pk_bf16_f32 v33, v114, v115
    v_cvt_pk_bf16_f32 v34, v116, v117
    v_mfma_f32_32x32x16_bf16 v[80:95], a[160:163], a[104:107], v[80:95]
    ds_read_b128 a[88:91], v2 offset:44640
    v_cvt_pk_bf16_f32 v35, v118, v119
    v_cvt_pk_bf16_f32 v36, v120, v121
    v_cvt_pk_bf16_f32 v37, v122, v123
    s_waitcnt lgkmcnt(3)
    v_mfma_f32_32x32x16_bf16 v[80:95], a[164:167], a[108:111], v[80:95]
    ds_read_b128 a[92:95], v2 offset:45296
    v_cvt_pk_bf16_f32 v38, v124, v125
    v_cvt_pk_bf16_f32 v39, v126, v127
    v_permlane32_swap_b32 v32, v34
    v_mfma_f32_32x32x16_bf16 v[80:95], a[168:171], a[112:115], v[80:95]
    ds_read_b128 a[96:99], v2 offset:13120
    v_permlane32_swap_b32 v33, v35
    v_permlane32_swap_b32 v36, v38
    v_mfma_f32_32x32x16_bf16 v[80:95], a[172:175], a[116:119], v[80:95]
    ds_read_b128 a[100:103], v2 offset:13776
    v_permlane32_swap_b32 v37, v39
    v_mfma_f32_32x32x16_bf16 v[80:95], a[176:179], a[72:75], v[80:95]
    ds_read_b128 a[104:107], v2 offset:14432
    buffer_store_dwordx4 v[32:35], v14, s[40:43], s61 offen offset:2048 sc1
    v_add_f32 v40, v40, v112
    v_fmac_f32 v42, v112, v112
    v_mfma_f32_32x32x16_bf16 v[80:95], a[180:183], a[76:79], v[80:95]
    ds_read_b128 a[108:111], v2 offset:13136
    v_add_f32 v41, v41, v113
    v_fmac_f32 v43, v113, v113
    v_add_f32 v40, v40, v114
    v_fmac_f32 v42, v114, v114
    s_waitcnt lgkmcnt(3)
    v_mfma_f32_32x32x16_bf16 v[80:95], a[184:187], a[80:83], v[80:95]
    ds_read_b128 a[112:115], v2 offset:13792
    v_add_f32 v41, v41, v115
    v_fmac_f32 v43, v115, v115
    v_add_f32 v40, v40, v116
    v_fmac_f32 v42, v116, v116
    v_add_f32 v41, v41, v117
    v_mfma_f32_32x32x16_bf16 v[80:95], a[188:191], a[84:87], v[80:95]
    ds_read_b128 a[116:119], v2 offset:14448
    v_fmac_f32 v43, v117, v117
    v_add_f32 v40, v40, v118
    v_fmac_f32 v42, v118, v118
    v_add_f32 v41, v41, v119
    v_fmac_f32 v43, v119, v119
    v_mfma_f32_32x32x16_bf16 v[80:95], a[192:195], a[88:91], v[80:95]
    ds_read_b128 a[72:75], v2 offset:13152
    v_add_f32 v40, v40, v120
    v_fmac_f32 v42, v120, v120
    v_add_f32 v41, v41, v121
    v_fmac_f32 v43, v121, v121
    v_add_f32 v40, v40, v122
    v_mfma_f32_32x32x16_bf16 v[80:95], a[196:199], a[92:95], v[80:95]
    ds_read_b128 a[76:79], v2 offset:13808
    v_fmac_f32 v42, v122, v122
    v_add_f32 v41, v41, v123
    v_fmac_f32 v43, v123, v123
    v_add_f32 v40, v40, v124
    v_fmac_f32 v42, v124, v124
    v_mfma_f32_32x32x16_bf16 v[96:111], a[128:131], a[96:99], v[96:111]
    ds_read_b128 a[80:83], v2 offset:14464
    buffer_store_dwordx4 v[36:39], v14, s[40:43], s79 offen offset:2048 sc1
    v_add_f32 v41, v41, v125
    s_waitcnt lgkmcnt(3)
    v_mfma_f32_32x32x16_bf16 v[96:111], a[132:135], a[100:103], v[96:111]
    ds_read_b128 a[84:87], v2 offset:44608
    v_fmac_f32 v43, v125, v125
    v_add_f32 v40, v40, v126
    v_fmac_f32 v42, v126, v126
    v_add_f32 v41, v41, v127
    v_fmac_f32 v43, v127, v127
    v_mfma_f32_32x32x16_bf16 v[96:111], a[136:139], a[104:107], v[96:111]
    ds_read_b128 a[88:91], v2 offset:45264
    v_mfma_f32_32x32x16_bf16 v[96:111], a[140:143], a[108:111], v[96:111]
    ds_read_b128 a[92:95], v2 offset:45920
    v_add_f32 v80, v80, v128
    v_add_f32 v81, v81, v129
    v_add_f32 v82, v82, v130
    v_add_f32 v40, v40, v74
    v_mfma_f32_32x32x16_bf16 v[96:111], a[144:147], a[112:115], v[96:111]
    ds_read_b128 a[96:99], v2 offset:44624
    v_add_f32 v83, v83, v131
    v_add_f32 v84, v84, v132
    v_add_f32 v85, v85, v133
    v_add_f32 v86, v86, v134
    v_mfma_f32_32x32x16_bf16 v[96:111], a[148:151], a[116:119], v[96:111]
    ds_read_b128 a[100:103], v2 offset:45280
    v_add_f32 v87, v87, v135
    v_add_f32 v88, v88, v136
    v_fmac_f32 v42, v74, v74
    v_add_f32 v41, v41, v75
    s_waitcnt lgkmcnt(3)
    v_mfma_f32_32x32x16_bf16 v[96:111], a[152:155], a[72:75], v[96:111]
    ds_read_b128 a[104:107], v2 offset:45936
    v_add_f32 v89, v89, v137
    v_add_f32 v90, v90, v138
    v_add_f32 v91, v91, v139
    v_add_f32 v92, v92, v140
    v_mfma_f32_32x32x16_bf16 v[96:111], a[156:159], a[76:79], v[96:111]
    ds_read_b128 a[108:111], v2 offset:44640
    v_add_f32 v93, v93, v141
    v_add_f32 v94, v94, v142
    v_add_f32 v95, v95, v143
    v_fmac_f32 v43, v75, v75
    v_mfma_f32_32x32x16_bf16 v[96:111], a[160:163], a[80:83], v[96:111]
    ds_read_b128 a[112:115], v2 offset:45296
    v_cvt_pk_bf16_f32 v224, v80, v81
    v_cvt_pk_bf16_f32 v225, v82, v83
    v_cvt_pk_bf16_f32 v228, v84, v85
    v_add_f32 v40, v40, v76
    v_mfma_f32_32x32x16_bf16 v[96:111], a[164:167], a[84:87], v[96:111]
    ds_read_b128 a[116:119], v2 offset:45952
    v_cvt_pk_bf16_f32 v229, v86, v87
    v_cvt_pk_bf16_f32 v232, v88, v89
    v_cvt_pk_bf16_f32 v233, v90, v91
    v_fmac_f32 v42, v76, v76
    v_mfma_f32_32x32x16_bf16 v[96:111], a[168:171], a[88:91], v[96:111]
    v_cvt_pk_bf16_f32 v236, v92, v93
    v_cvt_pk_bf16_f32 v237, v94, v95
    v_add_f32 v40, v40, v80
    v_fmac_f32 v42, v80, v80
    v_add_f32 v41, v41, v77
    s_waitcnt lgkmcnt(2)
    v_mfma_f32_32x32x16_bf16 v[96:111], a[172:175], a[92:95], v[96:111]
    v_add_f32 v41, v41, v81
    v_fmac_f32 v43, v81, v81
    v_add_f32 v40, v40, v82
    v_fmac_f32 v42, v82, v82
    v_add_f32 v41, v41, v83
    v_mfma_f32_32x32x16_bf16 v[96:111], a[176:179], a[96:99], v[96:111]
    v_fmac_f32 v43, v83, v83
    v_add_f32 v40, v40, v84
    v_fmac_f32 v42, v84, v84
    v_add_f32 v41, v41, v85
    v_fmac_f32 v43, v77, v77
    v_mfma_f32_32x32x16_bf16 v[96:111], a[180:183], a[100:103], v[96:111]
    v_fmac_f32 v43, v85, v85
    v_add_f32 v40, v40, v86
    v_fmac_f32 v42, v86, v86
    v_add_f32 v41, v41, v87
    v_add_f32 v40, v40, v78
    v_mfma_f32_32x32x16_bf16 v[96:111], a[184:187], a[104:107], v[96:111]
    v_fmac_f32 v43, v87, v87
    v_add_f32 v40, v40, v88
    v_fmac_f32 v42, v88, v88
    v_add_f32 v41, v41, v89
    v_fmac_f32 v43, v89, v89
    v_mfma_f32_32x32x16_bf16 v[96:111], a[188:191], a[108:111], v[96:111]
    v_add_f32 v40, v40, v90
    v_fmac_f32 v42, v90, v90
    v_add_f32 v41, v41, v91
    v_fmac_f32 v42, v78, v78
    v_add_f32 v41, v41, v79
    s_waitcnt lgkmcnt(0)
    v_mfma_f32_32x32x16_bf16 v[96:111], a[192:195], a[112:115], v[96:111]
    v_fmac_f32 v43, v91, v91
    v_add_f32 v40, v40, v92
    v_fmac_f32 v42, v92, v92
    v_add_f32 v41, v41, v93
    v_fmac_f32 v43, v93, v93
    v_mfma_f32_32x32x16_bf16 v[96:111], a[196:199], a[116:119], v[96:111]
    v_add_f32 v40, v40, v94
    v_fmac_f32 v42, v94, v94
    v_add_f32 v41, v41, v95
    v_fmac_f32 v43, v95, v95
    v_fmac_f32 v43, v79, v79
    buffer_load_dwordx4 v[48:51], v10, s[32:35], s60 offen sc1
    buffer_load_dwordx4 v[52:55], v10, s[32:35], s60 offen offset:2048 sc1
    s_nop 4
    v_pk_add_f32 v[96:97], v[96:97], v[128:129]
    v_pk_add_f32 v[98:99], v[98:99], v[130:131]
    v_pk_add_f32 v[100:101], v[100:101], v[132:133]
    v_pk_add_f32 v[102:103], v[102:103], v[134:135]
    v_pk_add_f32 v[104:105], v[104:105], v[136:137]
    v_pk_add_f32 v[106:107], v[106:107], v[138:139]
    v_pk_add_f32 v[108:109], v[108:109], v[140:141]
    v_pk_add_f32 v[110:111], v[110:111], v[142:143]
    v_pk_add_f32 v[40:41], v[40:41], v[96:97]
    v_pk_fma_f32 v[42:43], v[96:97], v[96:97], v[42:43]
    v_pk_add_f32 v[40:41], v[40:41], v[98:99]
    v_pk_fma_f32 v[42:43], v[98:99], v[98:99], v[42:43]
    v_pk_add_f32 v[40:41], v[40:41], v[100:101]
    v_pk_fma_f32 v[42:43], v[100:101], v[100:101], v[42:43]
    v_pk_add_f32 v[40:41], v[40:41], v[102:103]
    v_pk_fma_f32 v[42:43], v[102:103], v[102:103], v[42:43]
    v_pk_add_f32 v[40:41], v[40:41], v[104:105]
    v_pk_fma_f32 v[42:43], v[104:105], v[104:105], v[42:43]
    v_pk_add_f32 v[40:41], v[40:41], v[106:107]
    v_pk_fma_f32 v[42:43], v[106:107], v[106:107], v[42:43]
    v_pk_add_f32 v[40:41], v[40:41], v[108:109]
    v_pk_fma_f32 v[42:43], v[108:109], v[108:109], v[42:43]
    v_pk_add_f32 v[40:41], v[40:41], v[110:111]
    v_pk_fma_f32 v[42:43], v[110:111], v[110:111], v[42:43]
    v_add_f32 v26, v40, v41
    v_add_f32 v28, v42, v43
    v_mov_b32 v27, v8
    v_add_f32_dpp v26, v26, v26 row_ror:8 row_mask:0xf bank_mask:0xf
    v_add_f32_dpp v28, v28, v28 row_ror:8 row_mask:0xf bank_mask:0xf
    v_mov_b32 v29, v8
    v_add_f32_dpp v26, v26, v26 row_ror:4 row_mask:0xf bank_mask:0xf
    v_add_f32_dpp v28, v28, v28 row_ror:4 row_mask:0xf bank_mask:0xf
    v_mov_b32 v61, s85
    v_add_f32_dpp v26, v26, v26 row_ror:2 row_mask:0xf bank_mask:0xf
    v_add_f32_dpp v28, v28, v28 row_ror:2 row_mask:0xf bank_mask:0xf
    v_and_b32 v60, 3, v1
    v_add_f32_dpp v26, v26, v26 row_ror:1 row_mask:0xf bank_mask:0xf
    v_add_f32_dpp v28, v28, v28 row_ror:1 row_mask:0xf bank_mask:0xf
    v_lshlrev_b32 v60, 4, v60
    v_add_f32_dpp v26, v26, v26 row_bcast:15 row_mask:0xa bank_mask:0xf
    v_add_f32_dpp v28, v28, v28 row_bcast:15 row_mask:0xa bank_mask:0xf
    v_add_u32 v60, 126528, v60
    v_add_f32_dpp v26, v26, v26 row_bcast:31 row_mask:0xc bank_mask:0xf
    v_add_f32_dpp v28, v28, v28 row_bcast:31 row_mask:0xc bank_mask:0xf
    s_mov_b32 exec_lo, 0
    s_mov_b32 exec_hi, 0x10000
    ds_write_b128 v61, v[26:29]
    s_mov_b64 exec, -1
    s_waitcnt vmcnt(2) lgkmcnt(0)
    s_barrier
    ds_read_b128 v[56:59], v60
    s_waitcnt lgkmcnt(0)
    buffer_store_dwordx4 v[56:59], v9, s[32:35], s60 offen sc1
    v_cvt_pk_bf16_f32 v208, v96, v97
    v_cvt_pk_bf16_f32 v209, v98, v99
    v_cvt_pk_bf16_f32 v212, v100, v101
    v_cvt_pk_bf16_f32 v213, v102, v103
    v_cvt_pk_bf16_f32 v216, v104, v105
    v_cvt_pk_bf16_f32 v217, v106, v107
    v_cvt_pk_bf16_f32 v220, v108, v109
    v_cvt_pk_bf16_f32 v221, v110, v111
    buffer_store_dwordx4 v[224:227], v15, s[40:43], 0 offen offset:0 sc1
    buffer_store_dwordx4 v[228:231], v15, s[40:43], s76 offen offset:0 sc1
    buffer_store_dwordx4 v[232:235], v15, s[40:43], s77 offen offset:0 sc1
    buffer_store_dwordx4 v[236:239], v15, s[40:43], s78 offen offset:0 sc1
    buffer_store_dwordx4 v[208:211], v15, s[40:43], 0 offen offset:32 sc1
    buffer_store_dwordx4 v[212:215], v15, s[40:43], s76 offen offset:32 sc1
    buffer_store_dwordx4 v[216:219], v15, s[40:43], s77 offen offset:32 sc1
    buffer_store_dwordx4 v[220:223], v15, s[40:43], s78 offen offset:32 sc1
    s_mul_i32 s56, s70, 15744
    s_add_u32 s56, s56, 62976
    v_and_b32 v60, 31, v1
    v_lshrrev_b32 v61, 5, v1
    v_mul_u32_u24 v60, 272, v60
    v_lshl_add_u32 v60, v61, 3, v60
    v_add_u32 v60, s56, v60
    s_lshl_b32 s57, s70, 8
    s_add_u32 s57, s57, 127104
    v_lshl_add_u32 v62, v61, 3, s57
    ds_read_b64 v[192:193], v62 offset:0
    ds_read_b64 v[194:195], v62 offset:16
    ds_read_b64 v[196:197], v62 offset:32
    ds_read_b64 v[198:199], v62 offset:48
    ds_read_b64 v[200:201], v62 offset:64
    ds_read_b64 v[202:203], v62 offset:80
    ds_read_b64 v[204:205], v62 offset:96
    ds_read_b64 v[206:207], v62 offset:112
    ds_read_b64 v[208:209], v60 offset:0
    ds_read_b64 v[210:211], v60 offset:16
    ds_read_b64 v[212:213], v60 offset:32
    ds_read_b64 v[214:215], v60 offset:48
    ds_read_b64 v[216:217], v60 offset:64
    ds_read_b64 v[218:219], v60 offset:80
    ds_read_b64 v[220:221], v60 offset:96
    ds_read_b64 v[222:223], v60 offset:112
    ds_read_b64 v[32:33], v60 offset:128
    ds_read_b64 v[34:35], v60 offset:144
    ds_read_b64 v[36:37], v60 offset:160
    ds_read_b64 v[38:39], v60 offset:176
    ds_read_b64 v[40:41], v60 offset:192
    ds_read_b64 v[42:43], v60 offset:208
    ds_read_b64 v[44:45], v60 offset:224
    ds_read_b64 v[46:47], v60 offset:240
    s_waitcnt lgkmcnt(15)
    v_lshlrev_b32 v224, 16, v192
    v_and_b32 v225, s84, v192
    v_lshlrev_b32 v226, 16, v193
    v_and_b32 v227, s84, v193
    v_lshlrev_b32 v228, 16, v194
    v_and_b32 v229, s84, v194
    v_lshlrev_b32 v230, 16, v195
    v_and_b32 v231, s84, v195
    v_lshlrev_b32 v232, 16, v196
    v_and_b32 v233, s84, v196
    v_lshlrev_b32 v234, 16, v197
    v_and_b32 v235, s84, v197
    v_lshlrev_b32 v236, 16, v198
    v_and_b32 v237, s84, v198
    v_lshlrev_b32 v238, 16, v199
    v_and_b32 v239, s84, v199
    v_lshlrev_b32 v240, 16, v200
    v_and_b32 v241, s84, v200
    v_lshlrev_b32 v242, 16, v201
    v_and_b32 v243, s84, v201
    v_lshlrev_b32 v244, 16, v202
    v_and_b32 v245, s84, v202
    v_lshlrev_b32 v246, 16, v203
    v_and_b32 v247, s84, v203
    v_lshlrev_b32 v248, 16, v204
    v_and_b32 v249, s84, v204
    v_lshlrev_b32 v250, 16, v205
    v_and_b32 v251, s84, v205
    v_lshlrev_b32 v252, 16, v206
    v_and_b32 v253, s84, v206
    v_lshlrev_b32 v254, 16, v207
    v_and_b32 v255, s84, v207
    v_pk_mul_f32 v[240:241], v[240:241], s[86:87]
    v_pk_mul_f32 v[242:243], v[242:243], s[86:87]
    v_pk_mul_f32 v[244:245], v[244:245], s[86:87]
    v_pk_mul_f32 v[246:247], v[246:247], s[86:87]
    v_pk_mul_f32 v[248:249], v[248:249], s[86:87]
    v_pk_mul_f32 v[250:251], v[250:251], s[86:87]
    v_pk_mul_f32 v[252:253], v[252:253], s[86:87]
    v_pk_mul_f32 v[254:255], v[254:255], s[86:87]
    v_lshlrev_b32 v128, 16, v208
    v_and_b32 v129, s84, v208
    v_lshlrev_b32 v130, 16, v209
    v_and_b32 v131, s84, v209
    s_waitcnt lgkmcnt(14)
    v_lshlrev_b32 v132, 16, v210
    v_and_b32 v133, s84, v210
    v_lshlrev_b32 v134, 16, v211
    v_and_b32 v135, s84, v211
    s_waitcnt lgkmcnt(13)
    v_lshlrev_b32 v136, 16, v212
    v_and_b32 v137, s84, v212
    v_lshlrev_b32 v138, 16, v213
    v_and_b32 v139, s84, v213
    s_waitcnt lgkmcnt(12)
    v_lshlrev_b32 v140, 16, v214
    v_and_b32 v141, s84, v214
    v_lshlrev_b32 v142, 16, v215
    v_and_b32 v143, s84, v215
    s_waitcnt lgkmcnt(11)
    v_lshlrev_b32 v144, 16, v216
    v_and_b32 v145, s84, v216
    v_lshlrev_b32 v146, 16, v217
    v_and_b32 v147, s84, v217
    s_waitcnt lgkmcnt(10)
    v_lshlrev_b32 v148, 16, v218
    v_and_b32 v149, s84, v218
    v_lshlrev_b32 v150, 16, v219
    v_and_b32 v151, s84, v219
    s_waitcnt lgkmcnt(9)
    v_lshlrev_b32 v152, 16, v220
    v_and_b32 v153, s84, v220
    v_lshlrev_b32 v154, 16, v221
    v_and_b32 v155, s84, v221
    s_waitcnt lgkmcnt(8)
    v_lshlrev_b32 v156, 16, v222
    v_and_b32 v157, s84, v222
    v_lshlrev_b32 v158, 16, v223
    v_and_b32 v159, s84, v223
    s_waitcnt lgkmcnt(7)
    v_lshlrev_b32 v160, 16, v32
    v_and_b32 v161, s84, v32
    v_lshlrev_b32 v162, 16, v33
    v_and_b32 v163, s84, v33
    s_waitcnt lgkmcnt(6)
    v_lshlrev_b32 v164, 16, v34
    v_and_b32 v165, s84, v34
    v_lshlrev_b32 v166, 16, v35
    v_and_b32 v167, s84, v35
    s_waitcnt lgkmcnt(5)
    v_lshlrev_b32 v168, 16, v36
    v_and_b32 v169, s84, v36
    v_lshlrev_b32 v170, 16, v37
    v_and_b32 v171, s84, v37
    s_waitcnt lgkmcnt(4)
    v_lshlrev_b32 v172, 16, v38
    v_and_b32 v173, s84, v38
    v_lshlrev_b32 v174, 16, v39
    v_and_b32 v175, s84, v39
    s_waitcnt lgkmcnt(3)
    v_lshlrev_b32 v176, 16, v40
    v_and_b32 v177, s84, v40
    v_lshlrev_b32 v178, 16, v41
    v_and_b32 v179, s84, v41
    s_waitcnt lgkmcnt(2)
    v_lshlrev_b32 v180, 16, v42
    v_and_b32 v181, s84, v42
    v_lshlrev_b32 v182, 16, v43
    v_and_b32 v183, s84, v43
    s_waitcnt lgkmcnt(1)
    v_lshlrev_b32 v184, 16, v44
    v_and_b32 v185, s84, v44
    v_lshlrev_b32 v186, 16, v45
    v_and_b32 v187, s84, v45
    s_waitcnt lgkmcnt(0)
    v_lshlrev_b32 v188, 16, v46
    v_and_b32 v189, s84, v46
    v_lshlrev_b32 v190, 16, v47
    v_and_b32 v191, s84, v47
    v_pk_mul_f32 v[128:129], v[128:129], s[86:87]
    v_pk_mul_f32 v[130:131], v[130:131], s[86:87]
    v_pk_mul_f32 v[132:133], v[132:133], s[86:87]
    v_pk_mul_f32 v[134:135], v[134:135], s[86:87]
    v_pk_mul_f32 v[136:137], v[136:137], s[86:87]
    v_pk_mul_f32 v[138:139], v[138:139], s[86:87]
    v_pk_mul_f32 v[140:141], v[140:141], s[86:87]
    s_lshl_b32 s56, s71, 7
    s_add_u32 s56, s56, s74
    s_lshl_b32 s56, s56, 7
    s_add_u32 s56, s56, 4096
    v_and_b32 v62, 3, v1
    v_lshl_add_u32 v62, v62, 4, s56
    v_sub_u32 v62, v62, v10
    v_cmp_eq_u32 s[90:91], 0, v62
    v_cmp_eq_u32 vcc, 2048, v62
    s_waitcnt vmcnt(9)
    s_mov_b64 exec, s[90:91]
    v_mov_b64 v[48:49], v[56:57]
    v_mov_b64 v[50:51], v[58:59]
    s_mov_b64 exec, vcc
    v_mov_b64 v[52:53], v[56:57]
    v_mov_b64 v[54:55], v[58:59]
    s_mov_b64 exec, -1
    v_xor_b32 v60, v8, v49
    v_xor_b32 v61, v8, v51
    v_xor_b32 v62, v8, v53
    v_xor_b32 v63, v8, v55
    v_or_b32 v60, v60, v61
    v_or_b32 v62, v62, v63
    v_cmp_ne_u32 s[90:91], 0, v60
    v_cmp_ne_u32 s[96:97], 0, v62
    v_pk_mul_f32 v[142:143], v[142:143], s[86:87]
    v_pk_mul_f32 v[144:145], v[144:145], s[86:87]
    v_pk_mul_f32 v[146:147], v[146:147], s[86:87]
    v_pk_mul_f32 v[148:149], v[148:149], s[86:87]
    s_mov_b64 exec, s[90:91]
    buffer_load_dwordx4 v[48:51], v10, s[32:35], s60 offen sc1
    s_mov_b64 exec, s[96:97]
    buffer_load_dwordx4 v[52:55], v10, s[32:35], s60 offen offset:2048 sc1
    s_mov_b64 exec, -1
    v_pk_mul_f32 v[150:151], v[150:151], s[86:87]
    v_pk_mul_f32 v[152:153], v[152:153], s[86:87]
    v_pk_mul_f32 v[154:155], v[154:155], s[86:87]
    v_pk_mul_f32 v[156:157], v[156:157], s[86:87]
    v_pk_mul_f32 v[158:159], v[158:159], s[86:87]
    v_pk_mul_f32 v[160:161], v[160:161], s[86:87]
    v_pk_mul_f32 v[162:163], v[162:163], s[86:87]
    v_pk_mul_f32 v[164:165], v[164:165], s[86:87]
    v_pk_mul_f32 v[166:167], v[166:167], s[86:87]
    v_pk_mul_f32 v[168:169], v[168:169], s[86:87]
    v_pk_mul_f32 v[170:171], v[170:171], s[86:87]
    v_pk_mul_f32 v[172:173], v[172:173], s[86:87]
    v_pk_mul_f32 v[174:175], v[174:175], s[86:87]
    v_pk_mul_f32 v[176:177], v[176:177], s[86:87]
    v_pk_mul_f32 v[178:179], v[178:179], s[86:87]
    v_pk_mul_f32 v[180:181], v[180:181], s[86:87]
    v_pk_mul_f32 v[182:183], v[182:183], s[86:87]
    v_pk_mul_f32 v[184:185], v[184:185], s[86:87]
    v_pk_mul_f32 v[186:187], v[186:187], s[86:87]
    v_pk_mul_f32 v[188:189], v[188:189], s[86:87]
    v_pk_mul_f32 v[190:191], v[190:191], s[86:87]
    v_add_u32 v2, 62976, v2
    s_lshl_b32 s56, s70, 5
    s_add_u32 s56, s56, 128000
    v_and_b32 v192, 3, v1
    v_mul_u32_u24 v192, 160, v192
    v_lshrrev_b32 v193, 4, v1
    v_lshl_add_u32 v192, v193, 3, v192
    v_add_u32 v192, s56, v192
    s_mul_i32 s56, s70, 160
    s_add_u32 s56, s56, 128000
    v_and_b32 v193, 15, v1
    v_lshl_add_u32 v193, v193, 3, s56
    s_waitcnt vmcnt(0)
    s_nop 0
    v_xor_b32 v60, v8, v49
    v_xor_b32 v61, v8, v51
    v_xor_b32 v62, v8, v53
    v_xor_b32 v63, v8, v55
    v_or3_b32 v60, v60, v61, v62
    v_or_b32 v60, v60, v63
    v_cmp_ne_u32 vcc, 0, v60
    s_cbranch_vccz L_p2_ok
    s_mov_b32 s75, 0x4000
L_p2_re:
    v_xor_b32 v60, v8, v49
    v_xor_b32 v61, v8, v51
    v_or_b32 v60, v60, v61
    v_cmp_ne_u32 s[90:91], 0, v60
    v_xor_b32 v60, v8, v53
    v_xor_b32 v61, v8, v55
    v_or_b32 v60, v60, v61
    v_cmp_ne_u32 s[96:97], 0, v60
    s_nop 3
    s_or_b64 s[58:59], s[90:91], s[96:97]
    s_cbranch_scc0 L_p2_ok
    s_sub_u32 s75, s75, 1
    s_cbranch_scc1 L_p2_ok
    s_mov_b64 exec, s[90:91]
    buffer_load_dwordx4 v[48:51], v10, s[32:35], s60 offen sc1
    s_mov_b64 exec, s[96:97]
    buffer_load_dwordx4 v[52:55], v10, s[32:35], s60 offen offset:2048 sc1
    s_mov_b64 exec, -1
    s_waitcnt vmcnt(0)
    s_branch L_p2_re
L_p2_ok:
    v_add_f32 v48, v48, v52
    v_add_f32 v49, v50, v54
    s_nop 0
    v_add_f32_dpp v48, v48, v48 row_ror:8 row_mask:0xf bank_mask:0xf
    v_add_f32_dpp v49, v49, v49 row_ror:8 row_mask:0xf bank_mask:0xf
    s_nop 0
    v_add_f32_dpp v48, v48, v48 row_ror:4 row_mask:0xf bank_mask:0xf
    v_add_f32_dpp v49, v49, v49 row_ror:4 row_mask:0xf bank_mask:0xf
    s_mov_b32 exec_lo, 0x000f000f
    s_mov_b32 exec_hi, 0x000f000f
    ds_write_b64 v192, v[48:49]
    s_mov_b64 exec, -1
    s_waitcnt lgkmcnt(0)
    s_barrier
    ds_read_b64 v[48:49], v193
    buffer_load_dwordx4 v[196:199], v19, s[40:43], 0 offen sc1
    buffer_load_dwordx4 v[204:207], v19, s[40:43], s76 offen sc1
    buffer_load_dwordx4 v[212:215], v19, s[40:43], s77 offen sc1
    buffer_load_dwordx4 v[220:223], v19, s[40:43], s78 offen sc1
    s_waitcnt lgkmcnt(0)
    v_add_f32_dpp v48, v48, v48 row_ror:8 row_mask:0xf bank_mask:0xf
    v_add_f32_dpp v49, v49, v49 row_ror:8 row_mask:0xf bank_mask:0xf
    s_nop 0
    v_add_f32_dpp v48, v48, v48 row_ror:4 row_mask:0xf bank_mask:0xf
    v_add_f32_dpp v49, v49, v49 row_ror:4 row_mask:0xf bank_mask:0xf
    s_nop 0
    v_add_f32_dpp v48, v48, v48 row_ror:2 row_mask:0xf bank_mask:0xf
    v_add_f32_dpp v49, v49, v49 row_ror:2 row_mask:0xf bank_mask:0xf
    s_nop 0
    v_add_f32_dpp v48, v48, v48 row_ror:1 row_mask:0xf bank_mask:0xf
    v_add_f32_dpp v50, v49, v49 row_ror:1 row_mask:0xf bank_mask:0xf
    v_mul_f32 v60, 0x36000000, v48
    v_mul_f32 v61, 0x36000000, v50
    v_fma_f32 v61, -v60, v60, v61
    v_max_f32 v61, 0, v61
    v_mul_f32 v61, 0x3ef5fdf0, v61
    v_add_f32 v61, 0x3727c5ac, v61
    v_rsq_f32 v61, v61
    s_nop 0
    v_pk_mul_f32 v[224:225], v[224:225], v[60:61] op_sel:[0,1] op_sel_hi:[1,1]
    v_pk_mul_f32 v[226:227], v[226:227], v[60:61] op_sel:[0,1] op_sel_hi:[1,1]
    v_pk_mul_f32 v[228:229], v[228:229], v[60:61] op_sel:[0,1] op_sel_hi:[1,1]
    v_pk_mul_f32 v[230:231], v[230:231], v[60:61] op_sel:[0,1] op_sel_hi:[1,1]
    v_pk_mul_f32 v[232:233], v[232:233], v[60:61] op_sel:[0,1] op_sel_hi:[1,1]
    v_pk_mul_f32 v[234:235], v[234:235], v[60:61] op_sel:[0,1] op_sel_hi:[1,1]
    v_pk_mul_f32 v[236:237], v[236:237], v[60:61] op_sel:[0,1] op_sel_hi:[1,1]
    v_pk_mul_f32 v[238:239], v[238:239], v[60:61] op_sel:[0,1] op_sel_hi:[1,1]
    v_pk_fma_f32 v[240:241], v[224:225], v[60:61], v[240:241] op_sel:[0,0,0] op_sel_hi:[1,0,1] neg_lo:[0,1,0] neg_hi:[0,1,0]
    v_pk_fma_f32 v[242:243], v[226:227], v[60:61], v[242:243] op_sel:[0,0,0] op_sel_hi:[1,0,1] neg_lo:[0,1,0] neg_hi:[0,1,0]
    v_pk_fma_f32 v[244:245], v[228:229], v[60:61], v[244:245] op_sel:[0,0,0] op_sel_hi:[1,0,1] neg_lo:[0,1,0] neg_hi:[0,1,0]
    v_pk_fma_f32 v[246:247], v[230:231], v[60:61], v[246:247] op_sel:[0,0,0] op_sel_hi:[1,0,1] neg_lo:[0,1,0] neg_hi:[0,1,0]
    v_pk_fma_f32 v[248:249], v[232:233], v[60:61], v[248:249] op_sel:[0,0,0] op_sel_hi:[1,0,1] neg_lo:[0,1,0] neg_hi:[0,1,0]
    v_pk_fma_f32 v[250:251], v[234:235], v[60:61], v[250:251] op_sel:[0,0,0] op_sel_hi:[1,0,1] neg_lo:[0,1,0] neg_hi:[0,1,0]
    v_pk_fma_f32 v[252:253], v[236:237], v[60:61], v[252:253] op_sel:[0,0,0] op_sel_hi:[1,0,1] neg_lo:[0,1,0] neg_hi:[0,1,0]
    v_pk_fma_f32 v[254:255], v[238:239], v[60:61], v[254:255] op_sel:[0,0,0] op_sel_hi:[1,0,1] neg_lo:[0,1,0] neg_hi:[0,1,0]
    v_pk_fma_f32 v[64:65], v[64:65], v[224:225], v[240:241]
    v_pk_fma_f32 v[66:67], v[66:67], v[226:227], v[242:243]
    v_pk_fma_f32 v[80:81], v[80:81], v[224:225], v[240:241]
    buffer_load_dwordx2 v[192:193], v17, s[40:43], 0 offen sc1
    v_pk_fma_f32 v[82:83], v[82:83], v[226:227], v[242:243]
    v_exp_f32 v48, v64
    v_exp_f32 v49, v65
    v_exp_f32 v50, v66
    v_exp_f32 v51, v67
    v_exp_f32 v52, v80
    v_exp_f32 v53, v81
    buffer_load_dwordx2 v[194:195], v18, s[40:43], 0 offen sc1
    v_exp_f32 v54, v82
    v_exp_f32 v55, v83
    v_pk_add_f32 v[48:49], v[48:49], s[82:83]
    v_pk_add_f32 v[50:51], v[50:51], s[82:83]
    v_pk_add_f32 v[52:53], v[52:53], s[82:83]
    v_pk_add_f32 v[54:55], v[54:55], s[82:83]
    v_rcp_f32 v48, v48
    buffer_load_dwordx2 v[200:201], v17, s[40:43], s76 offen sc1
    v_rcp_f32 v49, v49
    v_rcp_f32 v50, v50
    v_rcp_f32 v51, v51
    v_rcp_f32 v52, v52
    v_rcp_f32 v53, v53
    v_rcp_f32 v54, v54
    v_rcp_f32 v55, v55
    v_pk_mul_f32 v[64:65], v[64:65], v[48:49]
    buffer_load_dwordx2 v[202:203], v18, s[40:43], s76 offen sc1
    v_pk_mul_f32 v[66:67], v[66:67], v[50:51]
    v_pk_mul_f32 v[80:81], v[80:81], v[52:53]
    v_pk_mul_f32 v[82:83], v[82:83], v[54:55]
    v_cvt_pk_bf16_f32 v56, v64, v65
    v_cvt_pk_bf16_f32 v57, v66, v67
    v_cvt_pk_bf16_f32 v58, v80, v81
    v_cvt_pk_bf16_f32 v59, v82, v83
    buffer_load_dwordx2 v[208:209], v17, s[40:43], s77 offen sc1
    ds_write_b64 v16, v[56:57] offset:0
    ds_write_b64 v16, v[58:59] offset:656
    v_pk_fma_f32 v[96:97], v[96:97], v[224:225], v[240:241]
    v_pk_fma_f32 v[98:99], v[98:99], v[226:227], v[242:243]
    v_pk_fma_f32 v[112:113], v[112:113], v[224:225], v[240:241]
    v_pk_fma_f32 v[114:115], v[114:115], v[226:227], v[242:243]
    v_exp_f32 v48, v96
    buffer_load_dwordx2 v[210:211], v18, s[40:43], s77 offen sc1
    v_exp_f32 v49, v97
    v_exp_f32 v50, v98
    v_exp_f32 v51, v99
    v_exp_f32 v52, v112
    v_exp_f32 v53, v113
    v_exp_f32 v54, v114
    v_exp_f32 v55, v115
    v_pk_add_f32 v[48:49], v[48:49], s[82:83]
    buffer_load_dwordx2 v[216:217], v17, s[40:43], s78 offen sc1
    v_pk_add_f32 v[50:51], v[50:51], s[82:83]
    v_pk_add_f32 v[52:53], v[52:53], s[82:83]
    v_pk_add_f32 v[54:55], v[54:55], s[82:83]
    v_rcp_f32 v48, v48
    v_rcp_f32 v49, v49
    v_rcp_f32 v50, v50
    v_rcp_f32 v51, v51
    buffer_load_dwordx2 v[218:219], v18, s[40:43], s78 offen sc1
    v_rcp_f32 v52, v52
    v_rcp_f32 v53, v53
    v_rcp_f32 v54, v54
    v_rcp_f32 v55, v55
    v_pk_mul_f32 v[96:97], v[96:97], v[48:49]
    v_pk_mul_f32 v[98:99], v[98:99], v[50:51]
    v_pk_mul_f32 v[112:113], v[112:113], v[52:53]
    v_pk_mul_f32 v[114:115], v[114:115], v[54:55]
    v_cvt_pk_bf16_f32 v56, v96, v97
    v_cvt_pk_bf16_f32 v57, v98, v99
    v_cvt_pk_bf16_f32 v58, v112, v113
    v_cvt_pk_bf16_f32 v59, v114, v115
    ds_write_b64 v16, v[56:57] offset:1312
    ds_write_b64 v16, v[58:59] offset:1968
    s_waitcnt lgkmcnt(0)
    s_barrier
    s_waitcnt lgkmcnt(0)
    v_add_u32 v7, 18432, v3
    ds_read_b128 a[72:75], v2 offset:672
    ds_read_b128 a[76:79], v2 offset:1328
    ds_read_b128 a[80:83], v2 offset:1984
    ds_read_b128 a[84:87], v2 offset:2640
    s_waitcnt lgkmcnt(1)
    v_mfma_f32_32x32x16_bf16 v[144:159], a[72:75], a[12:15], v[144:159]
    buffer_load_dwordx4 a[140:143], v7, s[36:39], 0 offen offset:3072 sc1
    v_mfma_f32_32x32x16_bf16 v[160:175], a[76:79], a[12:15], v[160:175]
    s_waitcnt vmcnt(9)
    v_xor_b32 v56, v8, v198
    v_xor_b32 v57, v8, v206
    v_xor_b32 v58, v8, v214
    v_xor_b32 v59, v8, v222
    v_or3_b32 v56, v56, v57, v58
    v_or_b32 v56, v56, v59
    v_mfma_f32_32x32x16_bf16 v[176:191], a[80:83], a[12:15], v[176:191]
    ds_read_b128 a[88:91], v2 offset:32160
    v_cmp_ne_u32 s[90:91], 0, v56
    v_cmp_le_u32 vcc, 8388608, v19
    s_nop 1
    s_and_b64 vcc, vcc, s[90:91]
    s_cbranch_vccz L_hc_ok
    s_mov_b32 s75, 0x4000
L_hc_re:
    buffer_load_dwordx4 v[196:199], v19, s[40:43], 0 offen sc1
    buffer_load_dwordx4 v[204:207], v19, s[40:43], s76 offen sc1
    buffer_load_dwordx4 v[212:215], v19, s[40:43], s77 offen sc1
    buffer_load_dwordx4 v[220:223], v19, s[40:43], s78 offen sc1
    s_waitcnt vmcnt(0)
    v_xor_b32 v56, v8, v198
    v_xor_b32 v57, v8, v206
    v_xor_b32 v58, v8, v214
    v_xor_b32 v59, v8, v222
    v_or3_b32 v56, v56, v57, v58
    v_or_b32 v56, v56, v59
    v_cmp_ne_u32 s[90:91], 0, v56
    v_cmp_le_u32 vcc, 8388608, v19
    s_nop 1
    s_and_b64 vcc, vcc, s[90:91]
    s_cbranch_vccz L_hc_ok
    s_sub_u32 s75, s75, 1
    s_cbranch_scc0 L_hc_re
L_hc_ok:
    v_lshlrev_b32 v32, 16, v196
    v_mfma_f32_32x32x16_bf16 v[128:143], a[72:75], a[16:19], v[128:143]
    ds_read_b128 a[92:95], v2 offset:32816
    buffer_load_dwordx4 a[144:147], v7, s[36:39], s61 offen offset:0 sc1
    v_and_b32 v33, s84, v196
    v_lshlrev_b32 v34, 16, v197
    v_and_b32 v35, s84, v197
    v_fma_f32 v32, v32, v224, v240
    v_mfma_f32_32x32x16_bf16 v[144:159], a[76:79], a[16:19], v[144:159]
    ds_read_b128 a[96:99], v2 offset:33472
    v_fma_f32 v33, v33, v225, v241
    v_fma_f32 v34, v34, v226, v242
    v_fma_f32 v35, v35, v227, v243
    v_exp_f32 v48, v32
    v_mfma_f32_32x32x16_bf16 v[160:175], a[80:83], a[16:19], v[160:175]
    v_exp_f32 v49, v33
    v_exp_f32 v50, v34
    v_exp_f32 v51, v35
    s_waitcnt lgkmcnt(2)
    v_mfma_f32_32x32x16_bf16 v[176:191], a[84:87], a[16:19], v[176:191]
    buffer_load_dwordx4 a[148:151], v7, s[36:39], s61 offen offset:1024 sc1
    v_add_f32 v48, 1.0, v48
    v_add_f32 v49, 1.0, v49
    v_add_f32 v50, 1.0, v50
    v_add_f32 v51, 1.0, v51
    v_rcp_f32 v48, v48
    v_mfma_f32_32x32x16_bf16 v[128:143], a[76:79], a[20:23], v[128:143]
    v_rcp_f32 v49, v49
    v_rcp_f32 v50, v50
    v_rcp_f32 v51, v51
    v_mul_f32 v32, v32, v48
    v_mfma_f32_32x32x16_bf16 v[144:159], a[80:83], a[20:23], v[144:159]
    ds_read_b128 a[100:103], v2 offset:34128
    v_mul_f32 v33, v33, v49
    v_mul_f32 v34, v34, v50
    v_mul_f32 v35, v35, v51
    v_cvt_pk_bf16_f32 v56, v32, v33
    v_cvt_pk_bf16_f32 v57, v34, v35
    v_mfma_f32_32x32x16_bf16 v[160:175], a[84:87], a[20:23], v[160:175]
    buffer_load_dwordx4 a[128:131], v7, s[36:39], 0 offen offset:0 sc1
    v_and_b32 v56, v56, v25
    v_and_b32 v57, v57, v25
    v_mfma_f32_32x32x16_bf16 v[144:159], a[88:91], a[48:51], v[144:159]
    ds_write_b64 v22, v[56:57] offset:0
    s_waitcnt lgkmcnt(2)
    v_mfma_f32_32x32x16_bf16 v[160:175], a[92:95], a[48:51], v[160:175]
    v_fma_f32 v68, v68, v228, v244
    v_fma_f32 v69, v69, v229, v245
    v_fma_f32 v70, v70, v230, v246
    v_fma_f32 v71, v71, v231, v247
    v_fma_f32 v84, v84, v228, v244
    v_mfma_f32_32x32x16_bf16 v[176:191], a[96:99], a[48:51], v[176:191]
    buffer_load_dwordx4 a[132:135], v7, s[36:39], 0 offen offset:1024 sc1
    v_fma_f32 v85, v85, v229, v245
    v_fma_f32 v86, v86, v230, v246
    v_fma_f32 v87, v87, v231, v247
    v_exp_f32 v48, v68
    v_mfma_f32_32x32x16_bf16 v[128:143], a[88:91], a[52:55], v[128:143]
    v_exp_f32 v49, v69
    v_exp_f32 v50, v70
    s_waitcnt lgkmcnt(0)
    s_barrier
    v_mfma_f32_32x32x16_bf16 v[144:159], a[92:95], a[52:55], v[144:159]
    ds_read_b128 a[104:107], v2 offset:656
    v_exp_f32 v51, v71
    v_exp_f32 v52, v84
    v_mfma_f32_32x32x16_bf16 v[160:175], a[96:99], a[52:55], v[160:175]
    ds_read_b128 a[108:111], v2 offset:1312
    buffer_load_dwordx4 a[136:139], v7, s[36:39], 0 offen offset:2048 sc1
    v_exp_f32 v53, v85
    v_mfma_f32_32x32x16_bf16 v[176:191], a[100:103], a[52:55], v[176:191]
    ds_read_b128 a[112:115], v2 offset:1968
    v_exp_f32 v54, v86
    v_exp_f32 v55, v87
    v_mfma_f32_32x32x16_bf16 v[128:143], a[92:95], a[56:59], v[128:143]
    v_add_f32 v48, 1.0, v48
    v_add_f32 v49, 1.0, v49
    v_add_f32 v50, 1.0, v50
    v_add_f32 v51, 1.0, v51
    v_add_f32 v52, 1.0, v52
    v_mfma_f32_32x32x16_bf16 v[144:159], a[96:99], a[56:59], v[144:159]
    ds_read_b128 a[116:119], v2 offset:2624
    buffer_load_dwordx4 a[152:155], v7, s[36:39], s61 offen offset:2048 sc1
    v_add_f32 v53, 1.0, v53
    v_add_f32 v54, 1.0, v54
    v_add_f32 v55, 1.0, v55
    v_mfma_f32_32x32x16_bf16 v[160:175], a[100:103], a[56:59], v[160:175]
    v_rcp_f32 v48, v48
    v_rcp_f32 v49, v49
    s_waitcnt lgkmcnt(1)
    v_mfma_f32_32x32x16_bf16 v[144:159], a[104:107], a[0:3], v[144:159]
    v_rcp_f32 v50, v50
    v_rcp_f32 v51, v51
    v_rcp_f32 v52, v52
    v_mfma_f32_32x32x16_bf16 v[160:175], a[108:111], a[0:3], v[160:175]
    buffer_load_dwordx4 a[156:159], v7, s[36:39], s61 offen offset:3072 sc1
    v_rcp_f32 v53, v53
    v_rcp_f32 v54, v54
    v_mfma_f32_32x32x16_bf16 v[176:191], a[112:115], a[0:3], v[176:191]
    ds_read_b128 a[72:75], v2 offset:688
    v_rcp_f32 v55, v55
    v_mul_f32 v68, v68, v48
    v_mul_f32 v69, v69, v49
    v_mul_f32 v70, v70, v50
    v_mfma_f32_32x32x16_bf16 v[128:143], a[104:107], a[4:7], v[128:143]
    ds_read_b128 a[76:79], v2 offset:1344
    v_mul_f32 v71, v71, v51
    v_mul_f32 v84, v84, v52
    v_mul_f32 v85, v85, v53
    v_mul_f32 v86, v86, v54
    v_mul_f32 v87, v87, v55
    v_mfma_f32_32x32x16_bf16 v[144:159], a[108:111], a[4:7], v[144:159]
    ds_read_b128 a[80:83], v2 offset:2000
    buffer_load_dwordx4 a[160:163], v7, s[36:39], s62 offen offset:0 sc1
    v_cvt_pk_bf16_f32 v56, v68, v69
    v_cvt_pk_bf16_f32 v57, v70, v71
    v_mfma_f32_32x32x16_bf16 v[160:175], a[112:115], a[4:7], v[160:175]
    v_cvt_pk_bf16_f32 v58, v84, v85
    v_cvt_pk_bf16_f32 v59, v86, v87
    s_waitcnt lgkmcnt(2)
    v_mfma_f32_32x32x16_bf16 v[176:191], a[116:119], a[4:7], v[176:191]
    ds_write_b64 v16, v[56:57] offset:3936
    v_mfma_f32_32x32x16_bf16 v[128:143], a[108:111], a[8:11], v[128:143]
    buffer_load_dwordx4 a[176:179], v7, s[36:39], s63 offen offset:0 sc1
    ds_write_b64 v16, v[58:59] offset:4592
    v_fma_f32 v100, v100, v228, v244
    v_fma_f32 v101, v101, v229, v245
    v_mfma_f32_32x32x16_bf16 v[144:159], a[112:115], a[8:11], v[144:159]
    ds_read_b128 a[84:87], v2 offset:2656
    v_fma_f32 v102, v102, v230, v246
    v_fma_f32 v103, v103, v231, v247
    v_fma_f32 v116, v116, v228, v244
    v_mfma_f32_32x32x16_bf16 v[160:175], a[116:119], a[8:11], v[160:175]
    v_fma_f32 v117, v117, v229, v245
    v_fma_f32 v118, v118, v230, v246
    v_fma_f32 v119, v119, v231, v247
    v_exp_f32 v48, v100
    v_mfma_f32_32x32x16_bf16 v[144:159], a[72:75], a[24:27], v[144:159]
    buffer_load_dwordx4 a[180:183], v7, s[36:39], s63 offen offset:1024 sc1
    v_exp_f32 v49, v101
    v_exp_f32 v50, v102
    s_waitcnt lgkmcnt(3)
    v_mfma_f32_32x32x16_bf16 v[160:175], a[76:79], a[24:27], v[160:175]
    v_exp_f32 v51, v103
    v_exp_f32 v52, v116
    v_exp_f32 v53, v117
    v_mfma_f32_32x32x16_bf16 v[176:191], a[80:83], a[24:27], v[176:191]
    ds_read_b128 a[88:91], v2 offset:32144
    v_exp_f32 v54, v118
    v_exp_f32 v55, v119
    v_add_f32 v48, 1.0, v48
    v_mfma_f32_32x32x16_bf16 v[128:143], a[72:75], a[28:31], v[128:143]
    ds_read_b128 a[92:95], v2 offset:32800
    buffer_load_dwordx4 a[184:187], v7, s[36:39], s63 offen offset:2048 sc1
    v_add_f32 v49, 1.0, v49
    v_add_f32 v50, 1.0, v50
    v_add_f32 v51, 1.0, v51
    v_add_f32 v52, 1.0, v52
    v_mfma_f32_32x32x16_bf16 v[144:159], a[76:79], a[28:31], v[144:159]
    ds_read_b128 a[96:99], v2 offset:33456
    v_add_f32 v53, 1.0, v53
    v_add_f32 v54, 1.0, v54
    v_add_f32 v55, 1.0, v55
    v_rcp_f32 v48, v48
    v_mfma_f32_32x32x16_bf16 v[160:175], a[80:83], a[28:31], v[160:175]
    v_rcp_f32 v49, v49
    v_rcp_f32 v50, v50
    s_waitcnt lgkmcnt(2)
    v_mfma_f32_32x32x16_bf16 v[176:191], a[84:87], a[28:31], v[176:191]
    buffer_load_dwordx4 a[164:167], v7, s[36:39], s62 offen offset:1024 sc1
    v_rcp_f32 v51, v51
    v_rcp_f32 v52, v52
    v_mfma_f32_32x32x16_bf16 v[128:143], a[76:79], a[32:35], v[128:143]
    v_rcp_f32 v53, v53
    v_rcp_f32 v54, v54
    v_rcp_f32 v55, v55
    v_mfma_f32_32x32x16_bf16 v[144:159], a[80:83], a[32:35], v[144:159]
    ds_read_b128 a[100:103], v2 offset:34112
    v_mul_f32 v100, v100, v48
    v_mul_f32 v101, v101, v49
    v_mul_f32 v102, v102, v50
    v_mul_f32 v103, v103, v51
    v_mul_f32 v116, v116, v52
    v_mfma_f32_32x32x16_bf16 v[160:175], a[84:87], a[32:35], v[160:175]
    buffer_load_dwordx4 a[168:171], v7, s[36:39], s62 offen offset:2048 sc1
    v_mul_f32 v117, v117, v53
    v_mul_f32 v118, v118, v54
    v_mul_f32 v119, v119, v55
    v_cvt_pk_bf16_f32 v56, v100, v101
    v_cvt_pk_bf16_f32 v57, v102, v103
    v_mfma_f32_32x32x16_bf16 v[144:159], a[88:91], a[36:39], v[144:159]
    v_cvt_pk_bf16_f32 v58, v116, v117
    v_cvt_pk_bf16_f32 v59, v118, v119
    s_waitcnt lgkmcnt(1)
    v_mfma_f32_32x32x16_bf16 v[160:175], a[92:95], a[36:39], v[160:175]
    ds_write_b64 v16, v[56:57] offset:5248
    v_mfma_f32_32x32x16_bf16 v[176:191], a[96:99], a[36:39], v[176:191]
    ds_read_b128 a[104:107], v2 offset:32176
    buffer_load_dwordx4 a[172:175], v7, s[36:39], s62 offen offset:3072 sc1
    ds_write_b64 v16, v[58:59] offset:5904
    v_lshlrev_b32 v32, 16, v204
    v_mfma_f32_32x32x16_bf16 v[128:143], a[88:91], a[40:43], v[128:143]
    ds_read_b128 a[108:111], v2 offset:32832
    v_and_b32 v33, s84, v204
    v_lshlrev_b32 v34, 16, v205
    v_and_b32 v35, s84, v205
    v_fma_f32 v32, v32, v228, v244
    v_fma_f32 v33, v33, v229, v245
    v_mfma_f32_32x32x16_bf16 v[144:159], a[92:95], a[40:43], v[144:159]
    ds_read_b128 a[112:115], v2 offset:33488
    v_fma_f32 v34, v34, v230, v246
    v_fma_f32 v35, v35, v231, v247
    v_exp_f32 v48, v32
    v_mfma_f32_32x32x16_bf16 v[160:175], a[96:99], a[40:43], v[160:175]
    buffer_load_dwordx4 a[188:191], v7, s[36:39], s63 offen offset:3072 sc1
    v_exp_f32 v49, v33
    v_exp_f32 v50, v34
    s_waitcnt lgkmcnt(3)
    v_mfma_f32_32x32x16_bf16 v[176:191], a[100:103], a[40:43], v[176:191]
    v_exp_f32 v51, v35
    v_add_f32 v48, 1.0, v48
    v_add_f32 v49, 1.0, v49
    v_add_f32 v50, 1.0, v50
    v_add_f32 v51, 1.0, v51
    v_mfma_f32_32x32x16_bf16 v[128:143], a[92:95], a[44:47], v[128:143]
    v_rcp_f32 v48, v48
    v_rcp_f32 v49, v49
    v_rcp_f32 v50, v50
    v_mfma_f32_32x32x16_bf16 v[144:159], a[96:99], a[44:47], v[144:159]
    ds_read_b128 a[116:119], v2 offset:34144
    buffer_load_dwordx4 a[192:195], v7, s[36:39], s64 offen offset:0 sc1
    v_rcp_f32 v51, v51
    v_mul_f32 v32, v32, v48
    v_mul_f32 v33, v33, v49
    v_mfma_f32_32x32x16_bf16 v[160:175], a[100:103], a[44:47], v[160:175]
    v_mul_f32 v34, v34, v50
    v_mul_f32 v35, v35, v51
    v_cvt_pk_bf16_f32 v56, v32, v33
    v_cvt_pk_bf16_f32 v57, v34, v35
    v_and_b32 v56, v56, v25
    v_and_b32 v57, v57, v25
    v_mfma_f32_32x32x16_bf16 v[144:159], a[104:107], a[60:63], v[144:159]
    ds_write_b64 v22, v[56:57] offset:3936
    s_waitcnt vmcnt(16) lgkmcnt(2)
    v_mfma_f32_32x32x16_bf16 v[160:175], a[108:111], a[60:63], v[160:175]
    buffer_load_dwordx4 a[196:199], v7, s[36:39], s64 offen offset:1024 sc1
    v_lshlrev_b32 v32, 16, v192
    v_and_b32 v33, s84, v192
    v_lshlrev_b32 v34, 16, v193
    v_mfma_f32_32x32x16_bf16 v[176:191], a[112:115], a[60:63], v[176:191]
    v_and_b32 v35, s84, v193
    v_lshlrev_b32 v36, 16, v194
    v_and_b32 v37, s84, v194
    v_lshlrev_b32 v38, 16, v195
    v_mfma_f32_32x32x16_bf16 v[128:143], a[104:107], a[64:67], v[128:143]
    v_add_u32 v3, 36864, v3
    v_and_b32 v39, s84, v195
    v_fma_f32 v32, v32, v224, v240
    s_waitcnt lgkmcnt(0)
    s_barrier
    v_mfma_f32_32x32x16_bf16 v[144:159], a[108:111], a[64:67], v[144:159]
    ds_read_b128 a[72:75], v2 offset:4608
    buffer_load_dwordx4 a[4:7], v3, s[36:39], 0 offen offset:1024 sc1
    v_fma_f32 v33, v33, v225, v241
    v_fma_f32 v34, v34, v226, v242
    v_mfma_f32_32x32x16_bf16 v[160:175], a[112:115], a[64:67], v[160:175]
    ds_read_b128 a[76:79], v2 offset:5264
    v_fma_f32 v35, v35, v227, v243
    v_fma_f32 v36, v36, v224, v240
    v_fma_f32 v37, v37, v225, v241
    s_waitcnt vmcnt(16)
    v_mfma_f32_32x32x16_bf16 v[176:191], a[116:119], a[64:67], v[176:191]
    ds_read_b128 a[80:83], v2 offset:5920
    v_fma_f32 v38, v38, v226, v242
    v_fma_f32 v39, v39, v227, v243
    v_exp_f32 v48, v32
    v_mfma_f32_32x32x16_bf16 v[128:143], a[108:111], a[68:71], v[128:143]
    buffer_load_dwordx4 a[16:19], v3, s[36:39], s61 offen offset:0 sc1
    v_exp_f32 v49, v33
    v_exp_f32 v50, v34
    v_mfma_f32_32x32x16_bf16 v[144:159], a[112:115], a[68:71], v[144:159]
    ds_read_b128 a[84:87], v2 offset:6576
    v_exp_f32 v51, v35
    v_exp_f32 v52, v36
    v_mfma_f32_32x32x16_bf16 v[160:175], a[116:119], a[68:71], v[160:175]
    v_exp_f32 v53, v37
    v_exp_f32 v54, v38
    s_waitcnt vmcnt(16) lgkmcnt(1)
    v_mfma_f32_32x32x16_bf16 v[144:159], a[72:75], a[140:143], v[144:159]
    buffer_load_dwordx4 a[28:31], v3, s[36:39], s61 offen offset:3072 sc1
    v_exp_f32 v55, v39
    v_add_f32 v48, 1.0, v48
    v_add_f32 v49, 1.0, v49
    v_add_f32 v50, 1.0, v50
    v_mfma_f32_32x32x16_bf16 v[160:175], a[76:79], a[140:143], v[160:175]
    v_add_f32 v51, 1.0, v51
    v_add_f32 v52, 1.0, v52
    v_add_f32 v53, 1.0, v53
    v_add_f32 v54, 1.0, v54
    v_add_f32 v55, 1.0, v55
    s_or_b32 s56, s2, s70
    v_mfma_f32_32x32x16_bf16 v[176:191], a[80:83], a[140:143], v[176:191]
    ds_read_b128 a[88:91], v2 offset:4592
    v_rcp_f32 v48, v48
    v_rcp_f32 v49, v49
    v_mfma_f32_32x32x16_bf16 v[128:143], a[72:75], a[144:147], v[128:143]
    ds_read_b128 a[92:95], v2 offset:5248
    buffer_load_dwordx4 a[40:43], v3, s[36:39], s62 offen offset:2048 sc1
    v_rcp_f32 v50, v50
    v_rcp_f32 v51, v51
    v_mfma_f32_32x32x16_bf16 v[144:159], a[76:79], a[144:147], v[144:159]
    ds_read_b128 a[96:99], v2 offset:5904
    v_rcp_f32 v52, v52
    v_rcp_f32 v53, v53
    s_mov_b32 s57, 4096
    v_mfma_f32_32x32x16_bf16 v[160:175], a[80:83], a[144:147], v[160:175]
    v_rcp_f32 v54, v54
    v_rcp_f32 v55, v55
    v_mul_f32 v32, v32, v48
    s_waitcnt vmcnt(16) lgkmcnt(2)
    v_mfma_f32_32x32x16_bf16 v[176:191], a[84:87], a[144:147], v[176:191]
    buffer_load_dwordx4 a[52:55], v3, s[36:39], s63 offen offset:1024 sc1
    v_mul_f32 v33, v33, v49
    v_mul_f32 v34, v34, v50
    v_mul_f32 v35, v35, v51
    v_mul_f32 v36, v36, v52
    s_cmp_eq_u32 s56, 0
    v_mfma_f32_32x32x16_bf16 v[128:143], a[76:79], a[148:151], v[128:143]
    v_mul_f32 v37, v37, v53
    v_mul_f32 v38, v38, v54
    v_mul_f32 v39, v39, v55
    v_cvt_pk_bf16_f32 v56, v32, v33
    v_cvt_pk_bf16_f32 v57, v34, v35
    v_cvt_pk_bf16_f32 v58, v36, v37
    v_mfma_f32_32x32x16_bf16 v[144:159], a[80:83], a[148:151], v[144:159]
    ds_read_b128 a[100:103], v2 offset:6560
    v_cvt_pk_bf16_f32 v59, v38, v39
    v_and_b32 v56, v56, v23
    v_and_b32 v57, v57, v23
    v_and_b32 v58, v58, v24
    s_cselect_b32 s56, s57, 2147483632
    v_mfma_f32_32x32x16_bf16 v[160:175], a[84:87], a[148:151], v[160:175]
    buffer_load_dwordx4 a[64:67], v3, s[36:39], s64 offen offset:0 sc1
    v_and_b32 v59, v59, v24
    s_mov_b32 s57, 8192
    s_mov_b32 s101, 0
    v_lshlrev_b32 v60, 7, v1
    v_mfma_f32_32x32x16_bf16 v[144:159], a[88:91], a[128:131], v[144:159]
    ds_write_b64 v20, v[56:57] offset:0
    v_add_u32 v60, s56, v60
    v_add_u32 v61, 16384, v60
    s_waitcnt vmcnt(17) lgkmcnt(2)
    v_mfma_f32_32x32x16_bf16 v[160:175], a[92:95], a[128:131], v[160:175]
    ds_write_b64 v21, v[58:59] offset:0
    v_add_u32 v7, 36864, v7
    v_lshlrev_b32 v32, 16, v200
    v_mfma_f32_32x32x16_bf16 v[176:191], a[96:99], a[128:131], v[176:191]
    ds_read_b128 a[104:107], v2 offset:4624
    buffer_load_dwordx4 a[144:147], v7, s[36:39], s61 offen offset:0 sc1
    v_and_b32 v33, s84, v200
    v_lshlrev_b32 v34, 16, v201
    v_and_b32 v35, s84, v201
    v_mfma_f32_32x32x16_bf16 v[128:143], a[88:91], a[132:135], v[128:143]
    ds_read_b128 a[108:111], v2 offset:5280
    buffer_load_dwordx2 v[40:41], v60, s[32:35], 0 offen sc1
    v_lshlrev_b32 v36, 16, v202
    v_and_b32 v37, s84, v202
    v_lshlrev_b32 v38, 16, v203
    v_and_b32 v39, s84, v203
    v_mfma_f32_32x32x16_bf16 v[144:159], a[92:95], a[132:135], v[144:159]
    ds_read_b128 a[112:115], v2 offset:5936
    v_fma_f32 v32, v32, v228, v244
    v_fma_f32 v33, v33, v229, v245
    v_fma_f32 v34, v34, v230, v246
    v_mfma_f32_32x32x16_bf16 v[160:175], a[96:99], a[132:135], v[160:175]
    v_fma_f32 v35, v35, v231, v247
    v_fma_f32 v36, v36, v228, v244
    v_fma_f32 v37, v37, v229, v245
    v_fma_f32 v38, v38, v230, v246
    s_waitcnt vmcnt(17) lgkmcnt(2)
    v_mfma_f32_32x32x16_bf16 v[176:191], a[100:103], a[132:135], v[176:191]
    buffer_load_dwordx4 a[132:135], v7, s[36:39], 0 offen offset:1024 sc1
    buffer_load_dwordx2 v[42:43], v60, s[32:35], s57 offen sc1
    v_fma_f32 v39, v39, v231, v247
    v_exp_f32 v48, v32
    v_exp_f32 v49, v33
    v_mfma_f32_32x32x16_bf16 v[128:143], a[92:95], a[136:139], v[128:143]
    buffer_load_dwordx2 v[44:45], v61, s[32:35], 0 offen sc1
    v_exp_f32 v50, v34
    v_exp_f32 v51, v35
    v_exp_f32 v52, v36
    v_mfma_f32_32x32x16_bf16 v[144:159], a[96:99], a[136:139], v[144:159]
    ds_read_b128 a[116:119], v2 offset:6592
    buffer_load_dwordx2 v[46:47], v61, s[32:35], s57 offen sc1
    v_exp_f32 v53, v37
    v_exp_f32 v54, v38
    v_mfma_f32_32x32x16_bf16 v[160:175], a[100:103], a[136:139], v[160:175]
    v_exp_f32 v55, v39
    v_add_f32 v48, 1.0, v48
    v_add_f32 v49, 1.0, v49
    v_add_f32 v50, 1.0, v50
    v_add_f32 v51, 1.0, v51
    v_mfma_f32_32x32x16_bf16 v[144:159], a[104:107], a[152:155], v[144:159]
    v_add_f32 v52, 1.0, v52
    v_add_f32 v53, 1.0, v53
    v_add_f32 v54, 1.0, v54
    v_add_f32 v55, 1.0, v55
    s_waitcnt vmcnt(20) lgkmcnt(1)
    v_mfma_f32_32x32x16_bf16 v[160:175], a[108:111], a[152:155], v[160:175]
    v_rcp_f32 v48, v48
    v_rcp_f32 v49, v49
    v_rcp_f32 v50, v50
    v_mfma_f32_32x32x16_bf16 v[176:191], a[112:115], a[152:155], v[176:191]
    ds_read_b128 a[72:75], v2 offset:36096
    v_rcp_f32 v51, v51
    v_rcp_f32 v52, v52
    v_mfma_f32_32x32x16_bf16 v[128:143], a[104:107], a[156:159], v[128:143]
    ds_read_b128 a[76:79], v2 offset:36752
    v_rcp_f32 v53, v53
    v_rcp_f32 v54, v54
    v_mfma_f32_32x32x16_bf16 v[144:159], a[108:111], a[156:159], v[144:159]
    ds_read_b128 a[80:83], v2 offset:37408
    v_rcp_f32 v55, v55
    v_mul_f32 v32, v32, v48
    v_mul_f32 v33, v33, v49
    v_mul_f32 v34, v34, v50
    v_mfma_f32_32x32x16_bf16 v[160:175], a[112:115], a[156:159], v[160:175]
    v_mul_f32 v35, v35, v51
    v_mul_f32 v36, v36, v52
    v_mul_f32 v37, v37, v53
    v_mul_f32 v38, v38, v54
    s_waitcnt vmcnt(18) lgkmcnt(2)
    v_mfma_f32_32x32x16_bf16 v[176:191], a[116:119], a[156:159], v[176:191]
    buffer_load_dwordx4 a[156:159], v7, s[36:39], s61 offen offset:3072 sc1
    v_mul_f32 v39, v39, v55
    v_cvt_pk_bf16_f32 v56, v32, v33
    v_cvt_pk_bf16_f32 v57, v34, v35
    v_cvt_pk_bf16_f32 v58, v36, v37
    v_mfma_f32_32x32x16_bf16 v[128:143], a[108:111], a[160:163], v[128:143]
    v_cvt_pk_bf16_f32 v59, v38, v39
    v_and_b32 v56, v56, v23
    v_and_b32 v57, v57, v23
    v_and_b32 v58, v58, v24
    v_and_b32 v59, v59, v24
    v_mfma_f32_32x32x16_bf16 v[144:159], a[112:115], a[160:163], v[144:159]
    ds_read_b128 a[84:87], v2 offset:38064
    ds_write_b64 v20, v[56:57] offset:3936
    v_mfma_f32_32x32x16_bf16 v[160:175], a[116:119], a[160:163], v[160:175]
    ds_write_b64 v21, v[58:59] offset:3936
    v_mfma_f32_32x32x16_bf16 v[144:159], a[72:75], a[176:179], v[144:159]
    v_fma_f32 v72, v72, v232, v248
    v_fma_f32 v73, v73, v233, v249
    v_fma_f32 v74, v74, v234, v250
    v_fma_f32 v75, v75, v235, v251
    s_waitcnt vmcnt(18) lgkmcnt(3)
    v_mfma_f32_32x32x16_bf16 v[160:175], a[76:79], a[176:179], v[160:175]
    v_fma_f32 v88, v88, v232, v248
    v_fma_f32 v89, v89, v233, v249
    v_fma_f32 v90, v90, v234, v250
    v_fma_f32 v91, v91, v235, v251
    v_exp_f32 v48, v72
    v_mfma_f32_32x32x16_bf16 v[176:191], a[80:83], a[176:179], v[176:191]
    ds_read_b128 a[88:91], v2 offset:36080
    v_exp_f32 v49, v73
    v_exp_f32 v50, v74
    v_mfma_f32_32x32x16_bf16 v[128:143], a[72:75], a[180:183], v[128:143]
    ds_read_b128 a[92:95], v2 offset:36736
    v_exp_f32 v51, v75
    v_exp_f32 v52, v88
    v_mfma_f32_32x32x16_bf16 v[144:159], a[76:79], a[180:183], v[144:159]
    ds_read_b128 a[96:99], v2 offset:37392
    v_exp_f32 v53, v89
    v_exp_f32 v54, v90
    v_mfma_f32_32x32x16_bf16 v[160:175], a[80:83], a[180:183], v[160:175]
    v_exp_f32 v55, v91
    v_add_f32 v48, 1.0, v48
    v_add_f32 v49, 1.0, v49
    v_add_f32 v50, 1.0, v50
    s_waitcnt vmcnt(16) lgkmcnt(2)
    v_mfma_f32_32x32x16_bf16 v[176:191], a[84:87], a[180:183], v[176:191]
    buffer_load_dwordx4 a[180:183], v7, s[36:39], s63 offen offset:1024 sc1
    v_add_f32 v51, 1.0, v51
    v_add_f32 v52, 1.0, v52
    v_add_f32 v53, 1.0, v53
    v_add_f32 v54, 1.0, v54
    v_mfma_f32_32x32x16_bf16 v[128:143], a[76:79], a[184:187], v[128:143]
    v_add_f32 v55, 1.0, v55
    v_rcp_f32 v48, v48
    v_rcp_f32 v49, v49
    v_mfma_f32_32x32x16_bf16 v[144:159], a[80:83], a[184:187], v[144:159]
    ds_read_b128 a[100:103], v2 offset:38048
    v_rcp_f32 v50, v50
    v_rcp_f32 v51, v51
    v_mfma_f32_32x32x16_bf16 v[160:175], a[84:87], a[184:187], v[160:175]
    v_rcp_f32 v52, v52
    v_rcp_f32 v53, v53
    v_rcp_f32 v54, v54
    v_mfma_f32_32x32x16_bf16 v[144:159], a[88:91], a[164:167], v[144:159]
    v_rcp_f32 v55, v55
    v_mul_f32 v72, v72, v48
    v_mul_f32 v73, v73, v49
    v_mul_f32 v74, v74, v50
    s_waitcnt vmcnt(16) lgkmcnt(1)
    v_mfma_f32_32x32x16_bf16 v[160:175], a[92:95], a[164:167], v[160:175]
    v_mul_f32 v75, v75, v51
    v_mul_f32 v88, v88, v52
    v_mul_f32 v89, v89, v53
    v_mul_f32 v90, v90, v54
    v_mul_f32 v91, v91, v55
    v_mfma_f32_32x32x16_bf16 v[176:191], a[96:99], a[164:167], v[176:191]
    ds_read_b128 a[104:107], v2 offset:36112
    v_cvt_pk_bf16_f32 v56, v72, v73
    v_cvt_pk_bf16_f32 v57, v74, v75
    v_cvt_pk_bf16_f32 v58, v88, v89
    v_mfma_f32_32x32x16_bf16 v[128:143], a[88:91], a[168:171], v[128:143]
    ds_read_b128 a[108:111], v2 offset:36768
    v_cvt_pk_bf16_f32 v59, v90, v91
    s_waitcnt vmcnt(2)
    v_xor_b32 v41, v8, v41
    v_xor_b32 v43, v8, v43
    v_xor_b32 v45, v8, v45
    v_mfma_f32_32x32x16_bf16 v[144:159], a[92:95], a[168:171], v[144:159]
    ds_read_b128 a[112:115], v2 offset:37424
    ds_write_b64 v16, v[56:57] offset:7872
    v_xor_b32 v47, v8, v47
    v_or3_b32 v41, v41, v43, v45
    v_mfma_f32_32x32x16_bf16 v[160:175], a[96:99], a[168:171], v[160:175]
    ds_write_b64 v16, v[58:59] offset:8528
    v_fma_f32 v104, v104, v232, v248
    v_fma_f32 v105, v105, v233, v249
    s_waitcnt lgkmcnt(4)
    v_mfma_f32_32x32x16_bf16 v[176:191], a[100:103], a[168:171], v[176:191]
    buffer_load_dwordx4 a[168:171], v7, s[36:39], s62 offen offset:2048 sc1
    v_fma_f32 v106, v106, v234, v250
    v_fma_f32 v107, v107, v235, v251
    v_fma_f32 v120, v120, v232, v248
    v_or_b32 v41, v41, v47
    v_mfma_f32_32x32x16_bf16 v[128:143], a[92:95], a[172:175], v[128:143]
    v_fma_f32 v121, v121, v233, v249
    v_fma_f32 v122, v122, v234, v250
    v_fma_f32 v123, v123, v235, v251
    v_exp_f32 v48, v104
    s_or_b32 s59, s2, s70
    v_mfma_f32_32x32x16_bf16 v[144:159], a[96:99], a[172:175], v[144:159]
    ds_read_b128 a[116:119], v2 offset:38080
    v_exp_f32 v49, v105
    v_exp_f32 v50, v106
    v_mfma_f32_32x32x16_bf16 v[160:175], a[100:103], a[172:175], v[160:175]
    v_exp_f32 v51, v107
    v_exp_f32 v52, v120
    v_exp_f32 v53, v121
    v_mfma_f32_32x32x16_bf16 v[144:159], a[104:107], a[188:191], v[144:159]
    v_exp_f32 v54, v122
    v_exp_f32 v55, v123
    v_add_f32 v48, 1.0, v48
    s_waitcnt lgkmcnt(3)
    v_mfma_f32_32x32x16_bf16 v[160:175], a[108:111], a[188:191], v[160:175]
    v_add_f32 v49, 1.0, v49
    v_add_f32 v50, 1.0, v50
    v_add_f32 v51, 1.0, v51
    v_add_f32 v52, 1.0, v52
    v_add_f32 v53, 1.0, v53
    v_add_f32 v54, 1.0, v54
    v_mfma_f32_32x32x16_bf16 v[176:191], a[112:115], a[188:191], v[176:191]
    v_add_f32 v55, 1.0, v55
    v_rcp_f32 v48, v48
    v_rcp_f32 v49, v49
    v_mfma_f32_32x32x16_bf16 v[128:143], a[104:107], a[192:195], v[128:143]
    v_rcp_f32 v50, v50
    v_rcp_f32 v51, v51
    s_barrier
    v_mfma_f32_32x32x16_bf16 v[144:159], a[108:111], a[192:195], v[144:159]
    ds_read_b128 a[72:75], v2 offset:0
    v_rcp_f32 v52, v52
    v_rcp_f32 v53, v53
    s_cmp_eq_u32 s59, 0
    v_mfma_f32_32x32x16_bf16 v[160:175], a[112:115], a[192:195], v[160:175]
    ds_read_b128 a[76:79], v2 offset:3280
    v_rcp_f32 v54, v54
    v_rcp_f32 v55, v55
    s_waitcnt lgkmcnt(2)
    v_mfma_f32_32x32x16_bf16 v[176:191], a[116:119], a[192:195], v[176:191]
    ds_read_b128 a[80:83], v2 offset:16
    buffer_load_dwordx4 a[192:195], v7, s[36:39], s64 offen offset:0 sc1
    v_mul_f32 v104, v104, v48
    v_mul_f32 v105, v105, v49
    v_mul_f32 v106, v106, v50
    v_mul_f32 v107, v107, v51
    v_mfma_f32_32x32x16_bf16 v[128:143], a[108:111], a[196:199], v[128:143]
    ds_read_b128 a[84:87], v2 offset:3296
    v_mul_f32 v120, v120, v52
    v_mul_f32 v121, v121, v53
    v_mul_f32 v122, v122, v54
    v_mul_f32 v123, v123, v55
    v_cvt_pk_bf16_f32 v56, v104, v105
    v_mfma_f32_32x32x16_bf16 v[144:159], a[112:115], a[196:199], v[144:159]
    ds_read_b128 a[88:91], v2 offset:32
    v_cvt_pk_bf16_f32 v57, v106, v107
    v_cvt_pk_bf16_f32 v58, v120, v121
    v_cvt_pk_bf16_f32 v59, v122, v123
    v_mfma_f32_32x32x16_bf16 v[160:175], a[116:119], a[196:199], v[160:175]
    ds_read_b128 a[92:95], v2 offset:3312
    ds_write_b64 v16, v[56:57] offset:9184
    s_cselect_b32 s59, 0, 2147483632
    s_waitcnt lgkmcnt(4)
    v_mfma_f32_32x32x16_bf16 v[128:143], a[72:75], a[0:3], v[128:143]
    ds_read_b128 a[96:99], v2 offset:31488
    buffer_load_dwordx4 a[0:3], v3, s[36:39], 0 offen offset:0 sc1
    ds_write_b64 v16, v[58:59] offset:9840
    v_lshlrev_b32 v32, 16, v212
    v_mfma_f32_32x32x16_bf16 v[176:191], a[76:79], a[8:11], v[176:191]
    ds_read_b128 a[100:103], v2 offset:34768
    v_and_b32 v33, s84, v212
    v_lshlrev_b32 v34, 16, v213
    v_and_b32 v35, s84, v213
    v_fma_f32 v32, v32, v232, v248
    v_fma_f32 v33, v33, v233, v249
    v_mfma_f32_32x32x16_bf16 v[128:143], a[80:83], a[12:15], v[128:143]
    ds_read_b128 a[104:107], v2 offset:31504
    v_fma_f32 v34, v34, v234, v250
    v_fma_f32 v35, v35, v235, v251
    v_exp_f32 v48, v32
    s_waitcnt lgkmcnt(5)
    v_mfma_f32_32x32x16_bf16 v[176:191], a[84:87], a[20:23], v[176:191]
    ds_read_b128 a[108:111], v2 offset:34784
    buffer_load_dwordx4 a[8:11], v3, s[36:39], 0 offen offset:2048 sc1
    v_exp_f32 v49, v33
    v_exp_f32 v50, v34
    v_mfma_f32_32x32x16_bf16 v[128:143], a[88:91], a[24:27], v[128:143]
    ds_read_b128 a[112:115], v2 offset:31520
    v_exp_f32 v51, v35
    v_add_f32 v48, 1.0, v48
    v_add_f32 v49, 1.0, v49
    v_add_f32 v50, 1.0, v50
    v_mfma_f32_32x32x16_bf16 v[176:191], a[92:95], a[32:35], v[176:191]
    ds_read_b128 a[116:119], v2 offset:34800
    v_add_f32 v51, 1.0, v51
    v_rcp_f32 v48, v48
    v_mov_b32 v60, 2147483632
    s_waitcnt lgkmcnt(3)
    v_mfma_f32_32x32x16_bf16 v[128:143], a[96:99], a[36:39], v[128:143]
    ds_read_b128 a[72:75], v2 offset:3936
    buffer_load_dwordx4 a[12:15], v3, s[36:39], 0 offen offset:3072 sc1
    v_rcp_f32 v49, v49
    v_rcp_f32 v50, v50
    v_mfma_f32_32x32x16_bf16 v[176:191], a[100:103], a[44:47], v[176:191]
    ds_read_b128 a[76:79], v2 offset:7216
    v_rcp_f32 v51, v51
    v_mul_f32 v32, v32, v48
    v_mul_f32 v33, v33, v49
    v_mul_f32 v34, v34, v50
    v_mfma_f32_32x32x16_bf16 v[128:143], a[104:107], a[48:51], v[128:143]
    ds_read_b128 a[80:83], v2 offset:3952
    v_mul_f32 v35, v35, v51
    v_cvt_pk_bf16_f32 v56, v32, v33
    v_cvt_pk_bf16_f32 v57, v34, v35
    v_and_b32 v56, v56, v25
    s_waitcnt lgkmcnt(3)
    v_mfma_f32_32x32x16_bf16 v[176:191], a[108:111], a[56:59], v[176:191]
    ds_read_b128 a[84:87], v2 offset:7232
    buffer_load_dwordx4 a[20:23], v3, s[36:39], s61 offen offset:1024 sc1
    v_and_b32 v57, v57, v25
    v_mov_b32 v61, s59
    v_mfma_f32_32x32x16_bf16 v[128:143], a[112:115], a[60:63], v[128:143]
    ds_read_b128 a[88:91], v2 offset:3968
    ds_write_b64 v22, v[56:57] offset:7872
    v_cmp_eq_u32 vcc, 0, v1
    s_nop 1
    v_cndmask_b32 v60, v60, v61, vcc
    v_mfma_f32_32x32x16_bf16 v[176:191], a[116:119], a[68:71], v[176:191]
    ds_read_b128 a[92:95], v2 offset:7248
    v_lshlrev_b32 v32, 16, v208
    v_and_b32 v33, s84, v208
    v_lshlrev_b32 v34, 16, v209
    s_waitcnt lgkmcnt(4)
    v_mfma_f32_32x32x16_bf16 v[128:143], a[72:75], a[128:131], v[128:143]
    ds_read_b128 a[96:99], v2 offset:35424
    buffer_load_dwordx4 a[24:27], v3, s[36:39], s61 offen offset:2048 sc1
    v_and_b32 v35, s84, v209
    v_lshlrev_b32 v36, 16, v210
    v_and_b32 v37, s84, v210
    v_mfma_f32_32x32x16_bf16 v[176:191], a[76:79], a[136:139], v[176:191]
    ds_read_b128 a[100:103], v2 offset:38704
    v_lshlrev_b32 v38, 16, v211
    v_and_b32 v39, s84, v211
    v_fma_f32 v32, v32, v232, v248
    v_fma_f32 v33, v33, v233, v249
    v_mfma_f32_32x32x16_bf16 v[128:143], a[80:83], a[140:143], v[128:143]
    ds_read_b128 a[104:107], v2 offset:35440
    v_fma_f32 v34, v34, v234, v250
    v_fma_f32 v35, v35, v235, v251
    v_fma_f32 v36, v36, v232, v248
    s_waitcnt lgkmcnt(3)
    v_mfma_f32_32x32x16_bf16 v[176:191], a[84:87], a[148:151], v[176:191]
    ds_read_b128 a[108:111], v2 offset:38720
    buffer_load_dwordx4 a[32:35], v3, s[36:39], s62 offen offset:0 sc1
    v_fma_f32 v37, v37, v233, v249
    v_fma_f32 v38, v38, v234, v250
    v_cmp_ne_u32 vcc, 0, v41
    s_cbranch_vccnz L_esw_no
    buffer_store_dword v8, v60, s[32:35], 0 offen sc1
    s_mov_b32 s101, 1
L_esw_no:
    v_mfma_f32_32x32x16_bf16 v[128:143], a[88:91], a[152:155], v[128:143]
    ds_read_b128 a[112:115], v2 offset:35456
    v_fma_f32 v39, v39, v235, v251
    v_exp_f32 v48, v32
    v_exp_f32 v49, v33
    v_mfma_f32_32x32x16_bf16 v[176:191], a[92:95], a[160:163], v[176:191]
    ds_read_b128 a[116:119], v2 offset:38736
    v_exp_f32 v50, v34
    s_barrier
    s_waitcnt lgkmcnt(3)
    v_mfma_f32_32x32x16_bf16 v[128:143], a[96:99], a[164:167], v[128:143]
    ds_read_b128 a[72:75], v2 offset:8528
    buffer_load_dwordx4 a[36:39], v3, s[36:39], s62 offen offset:1024 sc1
    v_exp_f32 v51, v35
    v_exp_f32 v52, v36
    v_mfma_f32_32x32x16_bf16 v[176:191], a[100:103], a[172:175], v[176:191]
    ds_read_b128 a[76:79], v2 offset:9184
    v_exp_f32 v53, v37
    v_exp_f32 v54, v38
    v_exp_f32 v55, v39
    v_mfma_f32_32x32x16_bf16 v[128:143], a[104:107], a[176:179], v[128:143]
    ds_read_b128 a[80:83], v2 offset:9840
    v_add_f32 v48, 1.0, v48
    v_add_f32 v49, 1.0, v49
    v_add_f32 v50, 1.0, v50
    v_add_f32 v51, 1.0, v51
    v_add_f32 v52, 1.0, v52
    s_waitcnt lgkmcnt(3)
    v_mfma_f32_32x32x16_bf16 v[176:191], a[108:111], a[184:187], v[176:191]
    buffer_load_dwordx4 a[44:47], v3, s[36:39], s62 offen offset:3072 sc1
    v_add_f32 v53, 1.0, v53
    v_add_f32 v54, 1.0, v54
    v_add_f32 v55, 1.0, v55
    v_rcp_f32 v48, v48
    v_mfma_f32_32x32x16_bf16 v[128:143], a[112:115], a[188:191], v[128:143]
    ds_read_b128 a[84:87], v2 offset:10496
    v_rcp_f32 v49, v49
    v_rcp_f32 v50, v50
    v_rcp_f32 v51, v51
    v_mfma_f32_32x32x16_bf16 v[176:191], a[116:119], a[196:199], v[176:191]
    v_rcp_f32 v52, v52
    v_rcp_f32 v53, v53
    v_rcp_f32 v54, v54
    s_waitcnt vmcnt(7) lgkmcnt(1)
    v_mfma_f32_32x32x16_bf16 v[144:159], a[72:75], a[0:3], v[144:159]
    buffer_load_dwordx4 a[48:51], v3, s[36:39], s63 offen offset:0 sc1
    v_rcp_f32 v55, v55
    v_mul_f32 v32, v32, v48
    v_mul_f32 v33, v33, v49
    v_mul_f32 v34, v34, v50
    v_mfma_f32_32x32x16_bf16 v[160:175], a[76:79], a[0:3], v[160:175]
    v_mul_f32 v35, v35, v51
    v_mul_f32 v36, v36, v52
    v_mul_f32 v37, v37, v53
    v_mul_f32 v38, v38, v54
    v_mul_f32 v39, v39, v55
    v_cvt_pk_bf16_f32 v56, v32, v33
    v_mfma_f32_32x32x16_bf16 v[176:191], a[80:83], a[0:3], v[176:191]
    ds_read_b128 a[88:91], v2 offset:8544
    v_cvt_pk_bf16_f32 v57, v34, v35
    v_cvt_pk_bf16_f32 v58, v36, v37
    v_cvt_pk_bf16_f32 v59, v38, v39
    v_and_b32 v56, v56, v23
    v_mfma_f32_32x32x16_bf16 v[128:143], a[72:75], a[4:7], v[128:143]
    ds_read_b128 a[92:95], v2 offset:9200
    buffer_load_dwordx4 a[56:59], v3, s[36:39], s63 offen offset:2048 sc1
    v_and_b32 v57, v57, v23
    v_and_b32 v58, v58, v24
    v_and_b32 v59, v59, v24
    v_mfma_f32_32x32x16_bf16 v[144:159], a[76:79], a[4:7], v[144:159]
    ds_read_b128 a[96:99], v2 offset:9856
    ds_write_b64 v20, v[56:57] offset:7872
    v_mfma_f32_32x32x16_bf16 v[160:175], a[80:83], a[4:7], v[160:175]
    ds_write_b64 v21, v[58:59] offset:7872
    s_waitcnt lgkmcnt(4)
    v_mfma_f32_32x32x16_bf16 v[176:191], a[84:87], a[4:7], v[176:191]
    buffer_load_dwordx4 a[60:63], v3, s[36:39], s63 offen offset:3072 sc1
    v_fma_f32 v76, v76, v236, v252
    v_fma_f32 v77, v77, v237, v253
    v_fma_f32 v78, v78, v238, v254
    s_waitcnt vmcnt(9) lgkmcnt(3)
    v_mfma_f32_32x32x16_bf16 v[128:143], a[76:79], a[8:11], v[128:143]
    v_fma_f32 v79, v79, v239, v255
    v_fma_f32 v92, v92, v236, v252
    v_fma_f32 v93, v93, v237, v253
    v_fma_f32 v94, v94, v238, v254
    v_fma_f32 v95, v95, v239, v255
    v_mfma_f32_32x32x16_bf16 v[144:159], a[80:83], a[8:11], v[144:159]
    ds_read_b128 a[100:103], v2 offset:10512
    v_exp_f32 v48, v76
    v_exp_f32 v49, v77
    v_mfma_f32_32x32x16_bf16 v[160:175], a[84:87], a[8:11], v[160:175]
    buffer_load_dwordx4 a[68:71], v3, s[36:39], s64 offen offset:1024 sc1
    v_exp_f32 v50, v78
    v_exp_f32 v51, v79
    s_waitcnt vmcnt(9) lgkmcnt(3)
    v_mfma_f32_32x32x16_bf16 v[144:159], a[88:91], a[12:15], v[144:159]
    v_exp_f32 v52, v92
    v_exp_f32 v53, v93
    v_exp_f32 v54, v94
    v_mfma_f32_32x32x16_bf16 v[160:175], a[92:95], a[12:15], v[160:175]
    v_exp_f32 v55, v95
    v_add_f32 v48, 1.0, v48
    v_add_f32 v49, 1.0, v49
    v_add_f32 v50, 1.0, v50
    v_mfma_f32_32x32x16_bf16 v[176:191], a[96:99], a[12:15], v[176:191]
    ds_read_b128 a[104:107], v2 offset:8560
    buffer_load_dwordx4 a[128:131], v7, s[36:39], 0 offen offset:0 sc1
    v_add_f32 v51, 1.0, v51
    v_add_f32 v52, 1.0, v52
    v_add_f32 v53, 1.0, v53
    v_add_f32 v54, 1.0, v54
    v_mfma_f32_32x32x16_bf16 v[128:143], a[88:91], a[16:19], v[128:143]
    ds_read_b128 a[108:111], v2 offset:9216
    v_add_f32 v55, 1.0, v55
    v_rcp_f32 v48, v48
    v_rcp_f32 v49, v49
    v_mfma_f32_32x32x16_bf16 v[144:159], a[92:95], a[16:19], v[144:159]
    ds_read_b128 a[112:115], v2 offset:9872
    v_rcp_f32 v50, v50
    v_rcp_f32 v51, v51
    v_mfma_f32_32x32x16_bf16 v[160:175], a[96:99], a[16:19], v[160:175]
    buffer_load_dwordx4 a[136:139], v7, s[36:39], 0 offen offset:2048 sc1
    v_rcp_f32 v52, v52
    v_rcp_f32 v53, v53
    s_waitcnt vmcnt(9) lgkmcnt(2)
    v_mfma_f32_32x32x16_bf16 v[176:191], a[100:103], a[16:19], v[176:191]
    v_rcp_f32 v54, v54
    v_rcp_f32 v55, v55
    v_mfma_f32_32x32x16_bf16 v[128:143], a[92:95], a[20:23], v[128:143]
    v_mul_f32 v76, v76, v48
    v_mul_f32 v77, v77, v49
    v_mul_f32 v78, v78, v50
    v_mul_f32 v79, v79, v51
    v_mul_f32 v92, v92, v52
    v_mul_f32 v93, v93, v53
    v_mfma_f32_32x32x16_bf16 v[144:159], a[96:99], a[20:23], v[144:159]
    ds_read_b128 a[116:119], v2 offset:10528
    buffer_load_dwordx4 a[140:143], v7, s[36:39], 0 offen offset:3072 sc1
    v_mul_f32 v94, v94, v54
    v_mul_f32 v95, v95, v55
    v_cvt_pk_bf16_f32 v56, v76, v77
    v_mfma_f32_32x32x16_bf16 v[160:175], a[100:103], a[20:23], v[160:175]
    v_cvt_pk_bf16_f32 v57, v78, v79
    v_cvt_pk_bf16_f32 v58, v92, v93
    v_cvt_pk_bf16_f32 v59, v94, v95
    v_mfma_f32_32x32x16_bf16 v[144:159], a[104:107], a[24:27], v[144:159]
    ds_write_b64 v16, v[56:57] offset:11808
    s_waitcnt vmcnt(9) lgkmcnt(2)
    v_mfma_f32_32x32x16_bf16 v[160:175], a[108:111], a[24:27], v[160:175]
    buffer_load_dwordx4 a[148:151], v7, s[36:39], s61 offen offset:1024 sc1
    ds_write_b64 v16, v[58:59] offset:12464
    v_fma_f32 v108, v108, v236, v252
    v_fma_f32 v109, v109, v237, v253
    v_mfma_f32_32x32x16_bf16 v[176:191], a[112:115], a[24:27], v[176:191]
    ds_read_b128 a[72:75], v2 offset:40016
    v_fma_f32 v110, v110, v238, v254
    v_fma_f32 v111, v111, v239, v255
    v_fma_f32 v124, v124, v236, v252
    v_mfma_f32_32x32x16_bf16 v[128:143], a[104:107], a[28:31], v[128:143]
    ds_read_b128 a[76:79], v2 offset:40672
    v_fma_f32 v125, v125, v237, v253
    v_fma_f32 v126, v126, v238, v254
    v_fma_f32 v127, v127, v239, v255
    v_exp_f32 v48, v108
    v_mfma_f32_32x32x16_bf16 v[144:159], a[108:111], a[28:31], v[144:159]
    ds_read_b128 a[80:83], v2 offset:41328
    buffer_load_dwordx4 a[152:155], v7, s[36:39], s61 offen offset:2048 sc1
    v_exp_f32 v49, v109
    v_exp_f32 v50, v110
    v_mfma_f32_32x32x16_bf16 v[160:175], a[112:115], a[28:31], v[160:175]
    v_exp_f32 v51, v111
    v_exp_f32 v52, v124
    s_waitcnt vmcnt(9) lgkmcnt(2)
    v_mfma_f32_32x32x16_bf16 v[176:191], a[116:119], a[28:31], v[176:191]
    v_exp_f32 v53, v125
    v_exp_f32 v54, v126
    v_exp_f32 v55, v127
    v_mfma_f32_32x32x16_bf16 v[128:143], a[108:111], a[32:35], v[128:143]
    buffer_load_dwordx4 a[160:163], v7, s[36:39], s62 offen offset:0 sc1
    v_add_f32 v48, 1.0, v48
    v_add_f32 v49, 1.0, v49
    v_add_f32 v50, 1.0, v50
    v_add_f32 v51, 1.0, v51
    v_add_f32 v52, 1.0, v52
    v_mfma_f32_32x32x16_bf16 v[144:159], a[112:115], a[32:35], v[144:159]
    ds_read_b128 a[84:87], v2 offset:41984
    v_add_f32 v53, 1.0, v53
    v_add_f32 v54, 1.0, v54
    v_add_f32 v55, 1.0, v55
    v_rcp_f32 v48, v48
    v_mfma_f32_32x32x16_bf16 v[160:175], a[116:119], a[32:35], v[160:175]
    v_rcp_f32 v49, v49
    v_rcp_f32 v50, v50
    v_rcp_f32 v51, v51
    v_mfma_f32_32x32x16_bf16 v[144:159], a[72:75], a[36:39], v[144:159]
    buffer_load_dwordx4 a[164:167], v7, s[36:39], s62 offen offset:1024 sc1
    v_rcp_f32 v52, v52
    v_rcp_f32 v53, v53
    s_waitcnt vmcnt(10) lgkmcnt(1)
    v_mfma_f32_32x32x16_bf16 v[160:175], a[76:79], a[36:39], v[160:175]
    v_rcp_f32 v54, v54
    v_rcp_f32 v55, v55
    v_mul_f32 v108, v108, v48
    v_mul_f32 v109, v109, v49
    v_mfma_f32_32x32x16_bf16 v[176:191], a[80:83], a[36:39], v[176:191]
    ds_read_b128 a[88:91], v2 offset:40032
    v_mul_f32 v110, v110, v50
    v_mul_f32 v111, v111, v51
    v_mul_f32 v124, v124, v52
    v_mul_f32 v125, v125, v53
    v_mul_f32 v126, v126, v54
    v_mfma_f32_32x32x16_bf16 v[128:143], a[72:75], a[40:43], v[128:143]
    ds_read_b128 a[92:95], v2 offset:40688
    buffer_load_dwordx4 a[172:175], v7, s[36:39], s62 offen offset:3072 sc1
    v_mul_f32 v127, v127, v55
    v_cvt_pk_bf16_f32 v56, v108, v109
    v_cvt_pk_bf16_f32 v57, v110, v111
    v_mfma_f32_32x32x16_bf16 v[144:159], a[76:79], a[40:43], v[144:159]
    ds_read_b128 a[96:99], v2 offset:41344
    v_cvt_pk_bf16_f32 v58, v124, v125
    v_cvt_pk_bf16_f32 v59, v126, v127
    v_mfma_f32_32x32x16_bf16 v[160:175], a[80:83], a[40:43], v[160:175]
    ds_write_b64 v16, v[56:57] offset:13120
    s_waitcnt vmcnt(10) lgkmcnt(3)
    v_mfma_f32_32x32x16_bf16 v[176:191], a[84:87], a[40:43], v[176:191]
    buffer_load_dwordx4 a[176:179], v7, s[36:39], s63 offen offset:0 sc1
    ds_write_b64 v16, v[58:59] offset:13776
    v_lshlrev_b32 v32, 16, v216
    v_mfma_f32_32x32x16_bf16 v[128:143], a[76:79], a[44:47], v[128:143]
    v_and_b32 v33, s84, v216
    v_lshlrev_b32 v34, 16, v217
    v_and_b32 v35, s84, v217
    v_lshlrev_b32 v36, 16, v218
    v_and_b32 v37, s84, v218
    v_mfma_f32_32x32x16_bf16 v[144:159], a[80:83], a[44:47], v[144:159]
    ds_read_b128 a[100:103], v2 offset:42000
    v_lshlrev_b32 v38, 16, v219
    v_and_b32 v39, s84, v219
    v_fma_f32 v32, v32, v236, v252
    v_fma_f32 v33, v33, v237, v253
    v_mfma_f32_32x32x16_bf16 v[160:175], a[84:87], a[44:47], v[160:175]
    buffer_load_dwordx4 a[184:187], v7, s[36:39], s63 offen offset:2048 sc1
    v_fma_f32 v34, v34, v238, v254
    v_fma_f32 v35, v35, v239, v255
    v_fma_f32 v36, v36, v236, v252
    v_mfma_f32_32x32x16_bf16 v[144:159], a[88:91], a[48:51], v[144:159]
    v_fma_f32 v37, v37, v237, v253
    v_fma_f32 v38, v38, v238, v254
    v_fma_f32 v39, v39, v239, v255
    v_exp_f32 v48, v32
    s_waitcnt vmcnt(11) lgkmcnt(3)
    v_mfma_f32_32x32x16_bf16 v[160:175], a[92:95], a[48:51], v[160:175]
    v_exp_f32 v49, v33
    v_exp_f32 v50, v34
    v_exp_f32 v51, v35
    v_mfma_f32_32x32x16_bf16 v[176:191], a[96:99], a[48:51], v[176:191]
    ds_read_b128 a[104:107], v2 offset:40048
    buffer_load_dwordx4 a[188:191], v7, s[36:39], s63 offen offset:3072 sc1
    v_exp_f32 v52, v36
    v_exp_f32 v53, v37
    v_mfma_f32_32x32x16_bf16 v[128:143], a[88:91], a[52:55], v[128:143]
    ds_read_b128 a[108:111], v2 offset:40704
    v_exp_f32 v54, v38
    v_exp_f32 v55, v39
    v_add_f32 v48, 1.0, v48
    v_mfma_f32_32x32x16_bf16 v[144:159], a[92:95], a[52:55], v[144:159]
    ds_read_b128 a[112:115], v2 offset:41360
    v_add_f32 v49, 1.0, v49
    v_add_f32 v50, 1.0, v50
    v_add_f32 v51, 1.0, v51
    v_add_f32 v52, 1.0, v52
    v_add_f32 v53, 1.0, v53
    v_mfma_f32_32x32x16_bf16 v[160:175], a[96:99], a[52:55], v[160:175]
    buffer_load_dwordx4 a[196:199], v7, s[36:39], s64 offen offset:1024 sc1
    v_add_f32 v54, 1.0, v54
    v_add_f32 v55, 1.0, v55
    v_rcp_f32 v48, v48
    s_waitcnt vmcnt(12) lgkmcnt(2)
    v_mfma_f32_32x32x16_bf16 v[176:191], a[100:103], a[52:55], v[176:191]
    v_rcp_f32 v49, v49
    v_rcp_f32 v50, v50
    v_rcp_f32 v51, v51
    v_mfma_f32_32x32x16_bf16 v[128:143], a[92:95], a[56:59], v[128:143]
    v_rcp_f32 v52, v52
    v_rcp_f32 v53, v53
    v_rcp_f32 v54, v54
    v_mfma_f32_32x32x16_bf16 v[144:159], a[96:99], a[56:59], v[144:159]
    ds_read_b128 a[116:119], v2 offset:42016
    v_rcp_f32 v55, v55
    v_mul_f32 v32, v32, v48
    v_mul_f32 v33, v33, v49
    v_mfma_f32_32x32x16_bf16 v[160:175], a[100:103], a[56:59], v[160:175]
    v_mul_f32 v34, v34, v50
    v_mul_f32 v35, v35, v51
    v_mul_f32 v36, v36, v52
    v_mul_f32 v37, v37, v53
    v_mul_f32 v38, v38, v54
    v_mul_f32 v39, v39, v55
    v_mfma_f32_32x32x16_bf16 v[144:159], a[104:107], a[60:63], v[144:159]
    v_cvt_pk_bf16_f32 v56, v32, v33
    v_cvt_pk_bf16_f32 v57, v34, v35
    v_cvt_pk_bf16_f32 v58, v36, v37
    v_cvt_pk_bf16_f32 v59, v38, v39
    s_waitcnt lgkmcnt(1)
    v_mfma_f32_32x32x16_bf16 v[160:175], a[108:111], a[60:63], v[160:175]
    v_and_b32 v56, v56, v23
    v_and_b32 v57, v57, v23
    v_and_b32 v58, v58, v24
    v_and_b32 v59, v59, v24
    v_mfma_f32_32x32x16_bf16 v[176:191], a[112:115], a[60:63], v[176:191]
    ds_write_b64 v20, v[56:57] offset:11808
    v_mfma_f32_32x32x16_bf16 v[128:143], a[104:107], a[64:67], v[128:143]
    ds_write_b64 v21, v[58:59] offset:11808
    v_lshlrev_b32 v32, 16, v220
    s_barrier
    v_mfma_f32_32x32x16_bf16 v[144:159], a[108:111], a[64:67], v[144:159]
    ds_read_b128 a[72:75], v2 offset:7872
    v_and_b32 v33, s84, v220
    v_lshlrev_b32 v34, 16, v221
    v_and_b32 v35, s84, v221
    v_fma_f32 v32, v32, v236, v252
    v_fma_f32 v33, v33, v237, v253
    v_mfma_f32_32x32x16_bf16 v[160:175], a[112:115], a[64:67], v[160:175]
    ds_read_b128 a[76:79], v2 offset:11152
    v_fma_f32 v34, v34, v238, v254
    v_fma_f32 v35, v35, v239, v255
    v_exp_f32 v48, v32
    s_waitcnt lgkmcnt(4)
    v_mfma_f32_32x32x16_bf16 v[176:191], a[116:119], a[64:67], v[176:191]
    ds_read_b128 a[80:83], v2 offset:7888
    v_exp_f32 v49, v33
    v_exp_f32 v50, v34
    v_mfma_f32_32x32x16_bf16 v[128:143], a[108:111], a[68:71], v[128:143]
    ds_read_b128 a[84:87], v2 offset:11168
    v_exp_f32 v51, v35
    v_add_f32 v48, 1.0, v48
    v_add_f32 v49, 1.0, v49
    v_add_f32 v50, 1.0, v50
    v_mfma_f32_32x32x16_bf16 v[144:159], a[112:115], a[68:71], v[144:159]
    ds_read_b128 a[88:91], v2 offset:7904
    v_add_f32 v51, 1.0, v51
    v_rcp_f32 v48, v48
    v_rcp_f32 v49, v49
    v_mfma_f32_32x32x16_bf16 v[160:175], a[116:119], a[68:71], v[160:175]
    ds_read_b128 a[92:95], v2 offset:11184
    v_rcp_f32 v50, v50
    v_rcp_f32 v51, v51
    s_waitcnt lgkmcnt(3)
    v_mfma_f32_32x32x16_bf16 v[128:143], a[72:75], a[0:3], v[128:143]
    ds_read_b128 a[96:99], v2 offset:39360
    v_mul_f32 v32, v32, v48
    v_mul_f32 v33, v33, v49
    v_mul_f32 v34, v34, v50
    v_mul_f32 v35, v35, v51
    v_cvt_pk_bf16_f32 v56, v32, v33
    v_mfma_f32_32x32x16_bf16 v[176:191], a[76:79], a[8:11], v[176:191]
    ds_read_b128 a[100:103], v2 offset:42640
    v_cvt_pk_bf16_f32 v57, v34, v35
    v_and_b32 v56, v56, v25
    v_and_b32 v57, v57, v25
    v_mfma_f32_32x32x16_bf16 v[128:143], a[80:83], a[12:15], v[128:143]
    ds_read_b128 a[104:107], v2 offset:39376
    ds_write_b64 v22, v[56:57] offset:11808
    s_waitcnt vmcnt(10) lgkmcnt(4)
    v_mfma_f32_32x32x16_bf16 v[176:191], a[84:87], a[20:23], v[176:191]
    ds_read_b128 a[108:111], v2 offset:42656
    v_mfma_f32_32x32x16_bf16 v[128:143], a[88:91], a[24:27], v[128:143]
    ds_read_b128 a[112:115], v2 offset:39392
    v_mfma_f32_32x32x16_bf16 v[176:191], a[92:95], a[32:35], v[176:191]
    ds_read_b128 a[116:119], v2 offset:42672
    s_waitcnt lgkmcnt(3)
    s_barrier
    s_waitcnt vmcnt(8)
    v_mfma_f32_32x32x16_bf16 v[128:143], a[96:99], a[36:39], v[128:143]
    ds_read_b128 a[72:75], v2 offset:11808
    v_mfma_f32_32x32x16_bf16 v[176:191], a[100:103], a[44:47], v[176:191]
    ds_read_b128 a[76:79], v2 offset:12464
    v_mfma_f32_32x32x16_bf16 v[128:143], a[104:107], a[48:51], v[128:143]
    ds_read_b128 a[80:83], v2 offset:13120
    s_waitcnt vmcnt(6) lgkmcnt(3)
    v_mfma_f32_32x32x16_bf16 v[176:191], a[108:111], a[56:59], v[176:191]
    ds_read_b128 a[84:87], v2 offset:11824
    v_mfma_f32_32x32x16_bf16 v[128:143], a[112:115], a[60:63], v[128:143]
    ds_read_b128 a[88:91], v2 offset:12480
    v_mfma_f32_32x32x16_bf16 v[176:191], a[116:119], a[68:71], v[176:191]
    ds_read_b128 a[92:95], v2 offset:13136
    s_waitcnt vmcnt(4) lgkmcnt(3)
    v_mfma_f32_32x32x16_bf16 v[128:143], a[72:75], a[128:131], v[128:143]
    ds_read_b128 a[96:99], v2 offset:11840
    v_mfma_f32_32x32x16_bf16 v[128:143], a[76:79], a[132:135], v[128:143]
    ds_read_b128 a[100:103], v2 offset:12496
    v_mfma_f32_32x32x16_bf16 v[128:143], a[80:83], a[136:139], v[128:143]
    ds_read_b128 a[104:107], v2 offset:13152
    s_waitcnt vmcnt(2) lgkmcnt(3)
    v_mfma_f32_32x32x16_bf16 v[128:143], a[84:87], a[140:143], v[128:143]
    ds_read_b128 a[108:111], v2 offset:43296
    v_mfma_f32_32x32x16_bf16 v[128:143], a[88:91], a[144:147], v[128:143]
    ds_read_b128 a[112:115], v2 offset:43952
    v_mfma_f32_32x32x16_bf16 v[128:143], a[92:95], a[148:151], v[128:143]
    ds_read_b128 a[116:119], v2 offset:44608
    s_waitcnt vmcnt(0) lgkmcnt(3)
    v_mfma_f32_32x32x16_bf16 v[128:143], a[96:99], a[152:155], v[128:143]
    ds_read_b128 a[72:75], v2 offset:43312
    v_mfma_f32_32x32x16_bf16 v[128:143], a[100:103], a[156:159], v[128:143]
    ds_read_b128 a[76:79], v2 offset:43968
    v_mfma_f32_32x32x16_bf16 v[128:143], a[104:107], a[160:163], v[128:143]
    ds_read_b128 a[80:83], v2 offset:44624
    s_waitcnt lgkmcnt(3)
    v_mfma_f32_32x32x16_bf16 v[128:143], a[108:111], a[164:167], v[128:143]
    ds_read_b128 a[84:87], v2 offset:43328
    v_mfma_f32_32x32x16_bf16 v[128:143], a[112:115], a[168:171], v[128:143]
    ds_read_b128 a[88:91], v2 offset:43984
    v_mfma_f32_32x32x16_bf16 v[128:143], a[116:119], a[172:175], v[128:143]
    ds_read_b128 a[92:95], v2 offset:44640
    s_waitcnt lgkmcnt(3)
    v_mfma_f32_32x32x16_bf16 v[128:143], a[72:75], a[176:179], v[128:143]
    ds_read_b128 a[96:99], v2 offset:12464
    v_mfma_f32_32x32x16_bf16 v[128:143], a[76:79], a[180:183], v[128:143]
    ds_read_b128 a[100:103], v2 offset:13120
    v_mfma_f32_32x32x16_bf16 v[128:143], a[80:83], a[184:187], v[128:143]
    ds_read_b128 a[104:107], v2 offset:13776
    s_waitcnt lgkmcnt(3)
    v_mfma_f32_32x32x16_bf16 v[128:143], a[84:87], a[188:191], v[128:143]
    ds_read_b128 a[108:111], v2 offset:12480
    v_mfma_f32_32x32x16_bf16 v[128:143], a[88:91], a[192:195], v[128:143]
    ds_read_b128 a[112:115], v2 offset:13136
    v_mfma_f32_32x32x16_bf16 v[128:143], a[92:95], a[196:199], v[128:143]
    ds_read_b128 a[116:119], v2 offset:13792
    s_waitcnt lgkmcnt(3)
    v_mfma_f32_32x32x16_bf16 v[144:159], a[96:99], a[128:131], v[144:159]
    ds_read_b128 a[72:75], v2 offset:12496
    v_mfma_f32_32x32x16_bf16 v[144:159], a[100:103], a[132:135], v[144:159]
    ds_read_b128 a[76:79], v2 offset:13152
    v_mfma_f32_32x32x16_bf16 v[144:159], a[104:107], a[136:139], v[144:159]
    ds_read_b128 a[80:83], v2 offset:13808
    s_nop 3
    v_mul_f32 v128, s88, v128
    v_mul_f32 v129, s88, v129
    s_waitcnt lgkmcnt(3)
    v_mfma_f32_32x32x16_bf16 v[144:159], a[108:111], a[140:143], v[144:159]
    ds_read_b128 a[84:87], v2 offset:43952
    v_mul_f32 v130, s88, v130
    v_mul_f32 v131, s88, v131
    v_mul_f32 v132, s88, v132
    v_mul_f32 v133, s88, v133
    v_mfma_f32_32x32x16_bf16 v[144:159], a[112:115], a[144:147], v[144:159]
    ds_read_b128 a[88:91], v2 offset:44608
    v_mul_f32 v134, s88, v134
    v_mul_f32 v135, s88, v135
    v_mul_f32 v136, s88, v136
    v_mfma_f32_32x32x16_bf16 v[144:159], a[116:119], a[148:151], v[144:159]
    ds_read_b128 a[92:95], v2 offset:45264
    v_mul_f32 v137, s88, v137
    v_mul_f32 v138, s88, v138
    s_waitcnt lgkmcnt(3)
    v_mfma_f32_32x32x16_bf16 v[144:159], a[72:75], a[152:155], v[144:159]
    ds_read_b128 a[96:99], v2 offset:43968
    v_mul_f32 v139, s88, v139
    v_mul_f32 v140, s88, v140
    v_mul_f32 v141, s88, v141
    v_mfma_f32_32x32x16_bf16 v[144:159], a[76:79], a[156:159], v[144:159]
    ds_read_b128 a[100:103], v2 offset:44624
    v_mul_f32 v142, s88, v142
    v_mul_f32 v143, s88, v143
    v_cvt_pk_bf16_f32 v32, v128, v129
    v_cvt_pk_bf16_f32 v33, v130, v131
    v_mfma_f32_32x32x16_bf16 v[144:159], a[80:83], a[160:163], v[144:159]
    ds_read_b128 a[104:107], v2 offset:45280
    v_cvt_pk_bf16_f32 v34, v132, v133
    v_cvt_pk_bf16_f32 v35, v134, v135
    s_waitcnt lgkmcnt(3)
    v_mfma_f32_32x32x16_bf16 v[144:159], a[84:87], a[164:167], v[144:159]
    ds_read_b128 a[108:111], v2 offset:43984
    v_cvt_pk_bf16_f32 v36, v136, v137
    v_cvt_pk_bf16_f32 v37, v138, v139
    v_cvt_pk_bf16_f32 v38, v140, v141
    v_mfma_f32_32x32x16_bf16 v[144:159], a[88:91], a[168:171], v[144:159]
    ds_read_b128 a[112:115], v2 offset:44640
    v_cvt_pk_bf16_f32 v39, v142, v143
    v_permlane32_swap_b32 v32, v34
    v_mfma_f32_32x32x16_bf16 v[144:159], a[92:95], a[172:175], v[144:159]
    ds_read_b128 a[116:119], v2 offset:45296
    v_permlane32_swap_b32 v33, v35
    s_waitcnt lgkmcnt(3)
    v_mfma_f32_32x32x16_bf16 v[144:159], a[96:99], a[176:179], v[144:159]
    ds_read_b128 a[72:75], v2 offset:13120
    v_permlane32_swap_b32 v36, v38
    v_permlane32_swap_b32 v37, v39
    v_mfma_f32_32x32x16_bf16 v[144:159], a[100:103], a[180:183], v[144:159]
    ds_read_b128 a[76:79], v2 offset:13776
    v_permlane16_swap_b32 v32, v36
    v_permlane16_swap_b32 v33, v37
    v_mfma_f32_32x32x16_bf16 v[144:159], a[104:107], a[184:187], v[144:159]
    ds_read_b128 a[80:83], v2 offset:14432
    v_permlane16_swap_b32 v34, v38
    s_waitcnt lgkmcnt(3)
    v_mfma_f32_32x32x16_bf16 v[144:159], a[108:111], a[188:191], v[144:159]
    ds_read_b128 a[84:87], v2 offset:13136
    v_permlane16_swap_b32 v35, v39
    v_mfma_f32_32x32x16_bf16 v[144:159], a[112:115], a[192:195], v[144:159]
    ds_read_b128 a[88:91], v2 offset:13792
    buffer_store_dwordx4 v[32:35], v13, s[44:47], 0 offen offset:0 sc0 sc1 nt
    v_mfma_f32_32x32x16_bf16 v[144:159], a[116:119], a[196:199], v[144:159]
    ds_read_b128 a[92:95], v2 offset:14448
    buffer_store_dwordx4 v[36:39], v13, s[44:47], s77 offen offset:0 sc0 sc1 nt
    s_waitcnt lgkmcnt(3)
    v_mfma_f32_32x32x16_bf16 v[160:175], a[72:75], a[128:131], v[160:175]
    ds_read_b128 a[96:99], v2 offset:13152
    v_mfma_f32_32x32x16_bf16 v[160:175], a[76:79], a[132:135], v[160:175]
    ds_read_b128 a[100:103], v2 offset:13808
    v_mfma_f32_32x32x16_bf16 v[160:175], a[80:83], a[136:139], v[160:175]
    ds_read_b128 a[104:107], v2 offset:14464
    s_nop 2
    v_mul_f32 v144, s88, v144
    v_mul_f32 v145, s88, v145
    s_waitcnt lgkmcnt(3)
    v_mfma_f32_32x32x16_bf16 v[160:175], a[84:87], a[140:143], v[160:175]
    ds_read_b128 a[108:111], v2 offset:44608
    v_mul_f32 v146, s88, v146
    v_mul_f32 v147, s88, v147
    v_mul_f32 v148, s88, v148
    v_mul_f32 v149, s88, v149
    v_mfma_f32_32x32x16_bf16 v[160:175], a[88:91], a[144:147], v[160:175]
    ds_read_b128 a[112:115], v2 offset:45264
    v_mul_f32 v150, s88, v150
    v_mul_f32 v151, s88, v151
    v_mul_f32 v152, s88, v152
    v_mfma_f32_32x32x16_bf16 v[160:175], a[92:95], a[148:151], v[160:175]
    ds_read_b128 a[116:119], v2 offset:45920
    v_mul_f32 v153, s88, v153
    v_mul_f32 v154, s88, v154
    s_waitcnt lgkmcnt(3)
    v_mfma_f32_32x32x16_bf16 v[160:175], a[96:99], a[152:155], v[160:175]
    ds_read_b128 a[72:75], v2 offset:44624
    v_mul_f32 v155, s88, v155
    v_mul_f32 v156, s88, v156
    v_mul_f32 v157, s88, v157
    v_mfma_f32_32x32x16_bf16 v[160:175], a[100:103], a[156:159], v[160:175]
    ds_read_b128 a[76:79], v2 offset:45280
    v_mul_f32 v158, s88, v158
    v_mul_f32 v159, s88, v159
    v_cvt_pk_bf16_f32 v32, v144, v145
    v_cvt_pk_bf16_f32 v33, v146, v147
    v_mfma_f32_32x32x16_bf16 v[160:175], a[104:107], a[160:163], v[160:175]
    ds_read_b128 a[80:83], v2 offset:45936
    v_cvt_pk_bf16_f32 v34, v148, v149
    v_cvt_pk_bf16_f32 v35, v150, v151
    s_waitcnt lgkmcnt(3)
    v_mfma_f32_32x32x16_bf16 v[160:175], a[108:111], a[164:167], v[160:175]
    ds_read_b128 a[84:87], v2 offset:44640
    v_cvt_pk_bf16_f32 v36, v152, v153
    v_cvt_pk_bf16_f32 v37, v154, v155
    v_cvt_pk_bf16_f32 v38, v156, v157
    v_mfma_f32_32x32x16_bf16 v[160:175], a[112:115], a[168:171], v[160:175]
    ds_read_b128 a[88:91], v2 offset:45296
    v_cvt_pk_bf16_f32 v39, v158, v159
    v_permlane32_swap_b32 v32, v34
    v_mfma_f32_32x32x16_bf16 v[160:175], a[116:119], a[172:175], v[160:175]
    ds_read_b128 a[92:95], v2 offset:45952
    v_permlane32_swap_b32 v33, v35
    s_waitcnt lgkmcnt(3)
    v_mfma_f32_32x32x16_bf16 v[160:175], a[72:75], a[176:179], v[160:175]
    ds_read_b128 a[96:99], v2 offset:13776
    v_permlane32_swap_b32 v36, v38
    v_permlane32_swap_b32 v37, v39
    v_mfma_f32_32x32x16_bf16 v[160:175], a[76:79], a[180:183], v[160:175]
    ds_read_b128 a[100:103], v2 offset:14432
    v_permlane16_swap_b32 v32, v36
    v_permlane16_swap_b32 v33, v37
    v_mfma_f32_32x32x16_bf16 v[160:175], a[80:83], a[184:187], v[160:175]
    ds_read_b128 a[104:107], v2 offset:15088
    v_permlane16_swap_b32 v34, v38
    s_waitcnt lgkmcnt(3)
    v_mfma_f32_32x32x16_bf16 v[160:175], a[84:87], a[188:191], v[160:175]
    ds_read_b128 a[108:111], v2 offset:13792
    v_permlane16_swap_b32 v35, v39
    v_mfma_f32_32x32x16_bf16 v[160:175], a[88:91], a[192:195], v[160:175]
    ds_read_b128 a[112:115], v2 offset:14448
    buffer_store_dwordx4 v[32:35], v13, s[44:47], 0 offen offset:256 sc0 sc1 nt
    v_mfma_f32_32x32x16_bf16 v[160:175], a[92:95], a[196:199], v[160:175]
    ds_read_b128 a[116:119], v2 offset:15104
    buffer_store_dwordx4 v[36:39], v13, s[44:47], s77 offen offset:256 sc0 sc1 nt
    s_waitcnt lgkmcnt(3)
    v_mfma_f32_32x32x16_bf16 v[176:191], a[96:99], a[128:131], v[176:191]
    ds_read_b128 a[72:75], v2 offset:13808
    v_mfma_f32_32x32x16_bf16 v[176:191], a[100:103], a[132:135], v[176:191]
    ds_read_b128 a[76:79], v2 offset:14464
    v_mfma_f32_32x32x16_bf16 v[176:191], a[104:107], a[136:139], v[176:191]
    ds_read_b128 a[80:83], v2 offset:15120
    s_nop 2
    v_mul_f32 v160, s88, v160
    v_mul_f32 v161, s88, v161
    s_waitcnt lgkmcnt(3)
    v_mfma_f32_32x32x16_bf16 v[176:191], a[108:111], a[140:143], v[176:191]
    ds_read_b128 a[84:87], v2 offset:45264
    v_mul_f32 v162, s88, v162
    v_mul_f32 v163, s88, v163
    v_mul_f32 v164, s88, v164
    v_mfma_f32_32x32x16_bf16 v[176:191], a[112:115], a[144:147], v[176:191]
    ds_read_b128 a[88:91], v2 offset:45920
    v_mul_f32 v165, s88, v165
    v_mul_f32 v166, s88, v166
    v_mul_f32 v167, s88, v167
    v_mfma_f32_32x32x16_bf16 v[176:191], a[116:119], a[148:151], v[176:191]
    ds_read_b128 a[92:95], v2 offset:46576
    v_mul_f32 v168, s88, v168
    v_mul_f32 v169, s88, v169
    s_waitcnt lgkmcnt(3)
    v_mfma_f32_32x32x16_bf16 v[176:191], a[72:75], a[152:155], v[176:191]
    ds_read_b128 a[96:99], v2 offset:45280
    v_mul_f32 v170, s88, v170
    v_mul_f32 v171, s88, v171
    v_mul_f32 v172, s88, v172
    v_mfma_f32_32x32x16_bf16 v[176:191], a[76:79], a[156:159], v[176:191]
    ds_read_b128 a[100:103], v2 offset:45936
    v_mul_f32 v173, s88, v173
    v_mul_f32 v174, s88, v174
    v_mfma_f32_32x32x16_bf16 v[176:191], a[80:83], a[160:163], v[176:191]
    ds_read_b128 a[104:107], v2 offset:46592
    v_mul_f32 v175, s88, v175
    v_cvt_pk_bf16_f32 v32, v160, v161
    s_waitcnt lgkmcnt(3)
    v_mfma_f32_32x32x16_bf16 v[176:191], a[84:87], a[164:167], v[176:191]
    ds_read_b128 a[108:111], v2 offset:45296
    v_cvt_pk_bf16_f32 v33, v162, v163
    v_cvt_pk_bf16_f32 v34, v164, v165
    v_cvt_pk_bf16_f32 v35, v166, v167
    v_mfma_f32_32x32x16_bf16 v[176:191], a[88:91], a[168:171], v[176:191]
    ds_read_b128 a[112:115], v2 offset:45952
    v_cvt_pk_bf16_f32 v36, v168, v169
    v_cvt_pk_bf16_f32 v37, v170, v171
    v_cvt_pk_bf16_f32 v38, v172, v173
    v_mfma_f32_32x32x16_bf16 v[176:191], a[92:95], a[172:175], v[176:191]
    ds_read_b128 a[116:119], v2 offset:46608
    v_cvt_pk_bf16_f32 v39, v174, v175
    v_permlane32_swap_b32 v32, v34
    s_waitcnt lgkmcnt(3)
    v_mfma_f32_32x32x16_bf16 v[176:191], a[96:99], a[176:179], v[176:191]
    v_permlane32_swap_b32 v33, v35
    v_permlane32_swap_b32 v36, v38
    v_mfma_f32_32x32x16_bf16 v[176:191], a[100:103], a[180:183], v[176:191]
    v_permlane32_swap_b32 v37, v39
    v_mfma_f32_32x32x16_bf16 v[176:191], a[104:107], a[184:187], v[176:191]
    v_permlane16_swap_b32 v32, v36
    v_permlane16_swap_b32 v33, v37
    s_waitcnt lgkmcnt(0)
    v_mfma_f32_32x32x16_bf16 v[176:191], a[108:111], a[188:191], v[176:191]
    v_permlane16_swap_b32 v34, v38
    v_permlane16_swap_b32 v35, v39
    v_mfma_f32_32x32x16_bf16 v[176:191], a[112:115], a[192:195], v[176:191]
    buffer_store_dwordx4 v[32:35], v13, s[44:47], 0 offen offset:512 sc0 sc1 nt
    v_mfma_f32_32x32x16_bf16 v[176:191], a[116:119], a[196:199], v[176:191]
    buffer_store_dwordx4 v[36:39], v13, s[44:47], s77 offen offset:512 sc0 sc1 nt
    s_nop 10
    v_pk_mul_f32 v[176:177], v[176:177], s[88:89]
    v_pk_mul_f32 v[178:179], v[178:179], s[88:89]
    v_pk_mul_f32 v[180:181], v[180:181], s[88:89]
    v_pk_mul_f32 v[182:183], v[182:183], s[88:89]
    v_pk_mul_f32 v[184:185], v[184:185], s[88:89]
    v_pk_mul_f32 v[186:187], v[186:187], s[88:89]
    v_pk_mul_f32 v[188:189], v[188:189], s[88:89]
    v_pk_mul_f32 v[190:191], v[190:191], s[88:89]
    v_cvt_pk_bf16_f32 v32, v176, v177
    v_cvt_pk_bf16_f32 v33, v178, v179
    v_cvt_pk_bf16_f32 v34, v180, v181
    v_cvt_pk_bf16_f32 v35, v182, v183
    v_cvt_pk_bf16_f32 v36, v184, v185
    v_cvt_pk_bf16_f32 v37, v186, v187
    v_cvt_pk_bf16_f32 v38, v188, v189
    v_cvt_pk_bf16_f32 v39, v190, v191
    v_permlane32_swap_b32 v32, v34
    v_permlane32_swap_b32 v33, v35
    v_permlane32_swap_b32 v36, v38
    v_permlane32_swap_b32 v37, v39
    s_nop 0
    v_permlane16_swap_b32 v32, v36
    v_permlane16_swap_b32 v33, v37
    v_permlane16_swap_b32 v34, v38
    v_permlane16_swap_b32 v35, v39
    buffer_store_dwordx4 v[32:35], v13, s[44:47], 0 offen offset:768 sc0 sc1 nt
    buffer_store_dwordx4 v[36:39], v13, s[44:47], s77 offen offset:768 sc0 sc1 nt
    s_or_b32 s56, s2, s70
    s_or_b32 s56, s56, s101
    s_cmp_lg_u32 s56, 0
    s_cbranch_scc1 L_noepoch
    s_mov_b32 s75, 0x1000
    v_lshlrev_b32 v60, 7, v1
    v_add_u32 v60, 36864, v60
    v_add_u32 v63, 16384, v60
    s_mov_b32 s56, 8192
L_ep_re:
    buffer_load_dwordx2 v[64:65], v60, s[32:35], 0 offen sc1
    buffer_load_dwordx2 v[66:67], v60, s[32:35], s56 offen sc1
    buffer_load_dwordx2 v[68:69], v63, s[32:35], 0 offen sc1
    buffer_load_dwordx2 v[70:71], v63, s[32:35], s56 offen sc1
    s_waitcnt vmcnt(0)
    v_xor_b32 v61, v8, v65
    v_xor_b32 v62, v8, v67
    v_or_b32 v61, v61, v62
    v_xor_b32 v62, v8, v69
    v_or_b32 v61, v61, v62
    v_xor_b32 v62, v8, v71
    v_or_b32 v61, v61, v62
    v_cmp_ne_u32 vcc, 0, v61
    s_cbranch_vccz L_ep_ok
    s_sub_u32 s75, s75, 1
    s_cbranch_scc0 L_ep_re
L_ep_ok:
    v_mov_b32 v60, 2147483632
    v_cmp_eq_u32 vcc, 0, v1
    s_nop 1
    v_cndmask_b32 v60, v60, 0, vcc
    buffer_store_dword v8, v60, s[32:35], 0 offen sc1
L_noepoch:
L_end:
    s_endpgm
L_codeend:

.section .rodata,"a"
.p2align 6
.amdhsa_kernel standalone__adm_resblock__diffusion_kernel
  .amdhsa_next_free_vgpr 456
  .amdhsa_next_free_sgpr 102
  .amdhsa_accum_offset 256
  .amdhsa_group_segment_fixed_size 0
  .amdhsa_kernarg_size 96
  .amdhsa_user_sgpr_count 2
  .amdhsa_user_sgpr_kernarg_segment_ptr 1
  .amdhsa_system_sgpr_workgroup_id_x 1
  .amdhsa_float_denorm_mode_32 3
.end_amdhsa_kernel
.text
```
